```python
import torch

def _softmax(x, axis=-1):
    return torch.softmax(x, dim=axis)
def _gelu(x):
    return torch.nn.functional.gelu(x, approximate="tanh")
def _silu(x):
    return torch.nn.functional.silu(x)
def _sigmoid(x):
    return torch.sigmoid(x)
def _layernorm(x, axis=-1, eps=1e-5):
    m = x.mean(dim=axis, keepdim=True)
    v = x.var(dim=axis, keepdim=True, unbiased=False)
    return (x - m) / torch.sqrt(v + eps)
def _scatter_add(tgt, idx, src, axis=0):
    return tgt.clone().index_add_(axis, idx, src)
def _segment_sum(src, seg, n):
    out = torch.zeros((n,) + src.shape[1:], dtype=src.dtype)
    return out.index_add_(0, seg, src)
def _pad(x, pw):
    flat = tuple(v for pair in reversed(pw) for v in pair)
    return torch.nn.functional.pad(x, flat)

kernel_name = 'standalone__cheap_equivariant_egnn__graph'

def setup_inputs():

    _w = (lambda a: (lambda t: t.to(torch.bfloat16) if t.is_floating_point() else t)(torch.as_tensor(a)))
    N, deg, D, De = 10000, 16, 256, max(0, 1)
    E = N * deg
    return {
        "h": _w((lambda *s: torch.randn(*s, dtype=torch.bfloat16) * 0.2)(N, D)),
        "pos": _w((lambda *s: torch.randn(*s, dtype=torch.bfloat16) * 0.8)(N, 3)),
        "e_attr": _w((lambda *s: torch.randn(*s, dtype=torch.bfloat16) * 0.8)(E, De)),
        "src": _w((lambda lo, hi, *s: torch.randint(lo, hi, s))(0, N, E).to(torch.int64)),
        "dst": _w((lambda lo, hi, *s: torch.randint(lo, hi, s))(0, N, E).to(torch.int64)),
        "w_e": _w(0.1 * (lambda *s: torch.randn(*s, dtype=torch.bfloat16) * 0.8)(2 * D + 1 + De, D)),
        "w_x": _w(0.1 * (lambda *s: torch.randn(*s, dtype=torch.bfloat16) * 0.2)(D, 1)),
        "w_h": _w(0.1 * (lambda *s: torch.randn(*s, dtype=torch.bfloat16) * 0.2)(2 * D, D)),
    }

def reference(h, pos, e_attr, src, dst, w_e, w_x, w_h):
    N, D = h.shape[0], h.shape[1]
    diff = pos[dst] - pos[src]
    dist2 = torch.sum(diff * diff, axis=-1, keepdims=True)
    e_in = torch.concatenate([h[dst], h[src], dist2, e_attr], axis=-1)
    m_ij = _silu(e_in @ w_e)
    coord_scale = m_ij @ w_x
    pos_new = pos + _segment_sum(diff * coord_scale, dst, N)
    m_i = _segment_sum(m_ij, dst, N)
    h_new = h + _silu(torch.concatenate([h, m_i], axis=-1) @ w_h)
    return h_new, pos_new
```

```asm
; @launch kernel=egnn_prep_kernel grid=(384,1,1) block=(256,1,1) lds=43520
; @launch kernel=egnn_edge_kernel grid=(256,1,1) block=(512,1,1) lds=148672
.amdgcn_target "amdgcn-amd-amdhsa--gfx950"
.text
.globl egnn_prep_kernel
.p2align 8
.type egnn_prep_kernel,@function
egnn_prep_kernel:
    s_cmp_ge_u32 s2, 384
    s_cbranch_scc1 egnn_prep_kernel_end
    s_load_dwordx16 s[4:19], s[0:1], 0
    s_load_dwordx2 s[20:21], s[0:1], 80
    v_lshrrev_b32 v1, 6, v0
    v_and_b32 v2, 63, v0
    v_readfirstlane_b32 s3, v1
    s_cmp_lt_u32 s2, 128
    s_cbranch_scc1 egnn_prep_kernel_bin
    s_sub_u32 s49, s2, 128
    s_lshr_b32 s22, s49, 3
    s_and_b32 s22, s22, 1
    s_lshr_b32 s23, s49, 4
    s_and_b32 s24, s49, 7
    s_mul_i32 s27, s24, 125
    s_add_u32 s26, s27, 125
    s_lshr_b32 s27, s27, 3
    s_lshr_b32 s26, s26, 3
    s_add_u32 s23, s23, s27
    s_mul_i32 s24, s24, 3
    s_add_u32 s24, s24, 2
    s_lshr_b32 s24, s24, 3
    s_add_u32 s24, s24, 125
    s_cmp_lt_u32 s23, s26
    s_cselect_b32 s23, s23, s24
    v_and_b32 v3, 15, v2
    v_lshrrev_b32 v4, 4, v2
    v_lshlrev_b32 v5, 2, v3
    v_lshl_add_u32 v5, v4, 12, v5
    s_mov_b32 s40, 0x05040100
    s_mov_b32 s41, 0x07060302
    s_cmp_ge_u32 s23, 125
    s_cbranch_scc1 egnn_prep_kernel_rep
    s_lshl_b32 s25, s22, 8
    s_lshl_b32 s26, s3, 6
    s_add_u32 s25, s25, s26
    s_mul_i32 s26, s23, 40960
    v_lshlrev_b32 v6, 4, v0
    s_waitcnt lgkmcnt(0)
    s_add_u32 s28, s4, s26
    s_addc_u32 s29, s5, 0
    s_mov_b32 s30, 40960
    s_mov_b32 s31, 0x20000
    s_add_u32 s27, s25, 131072
    s_add_u32 s32, s14, s27
    s_addc_u32 s33, s15, 0
    s_mov_b32 s34, 130624
    s_mov_b32 s35, 0x20000
    s_mov_b32 s42, 0
    buffer_load_dwordx4 v[8:11], v6, s[28:31], s42 offen
    s_add_u32 s42, s42, 4096
    buffer_load_dwordx4 v[12:15], v6, s[28:31], s42 offen
    s_add_u32 s42, s42, 4096
    buffer_load_dwordx4 v[16:19], v6, s[28:31], s42 offen
    s_add_u32 s42, s42, 4096
    buffer_load_dwordx4 v[20:23], v6, s[28:31], s42 offen
    s_add_u32 s42, s42, 4096
    buffer_load_dwordx4 v[24:27], v6, s[28:31], s42 offen
    s_add_u32 s42, s42, 4096
    buffer_load_dwordx4 v[28:31], v6, s[28:31], s42 offen
    s_add_u32 s42, s42, 4096
    buffer_load_dwordx4 v[32:35], v6, s[28:31], s42 offen
    s_add_u32 s42, s42, 4096
    buffer_load_dwordx4 v[36:39], v6, s[28:31], s42 offen
    s_add_u32 s42, s42, 4096
    buffer_load_dwordx4 v[40:43], v6, s[28:31], s42 offen
    s_add_u32 s42, s42, 4096
    buffer_load_dwordx4 v[44:47], v6, s[28:31], s42 offen
    s_mul_i32 s27, s23, 480
    s_cmp_eq_u32 s22, 0
    s_cselect_b32 s43, 480, 0
    s_add_u32 s36, s6, s27
    s_addc_u32 s37, s7, 0
    s_mov_b32 s38, s43
    s_mov_b32 s39, 0x20000
    v_mul_u32_u24 v7, 6, v0
    buffer_load_ushort v48, v7, s[36:39], 0 offen
    buffer_load_ushort v49, v7, s[36:39], 0 offen offset:2
    buffer_load_ushort v50, v7, s[36:39], 0 offen offset:4
    buffer_load_dword v64, v5, s[32:35], 0 offen offset:0
    buffer_load_dword v65, v5, s[32:35], 0 offen offset:512
    buffer_load_dword v66, v5, s[32:35], 0 offen offset:1024
    buffer_load_dword v67, v5, s[32:35], 0 offen offset:1536
    buffer_load_dword v68, v5, s[32:35], 0 offen offset:2048
    buffer_load_dword v69, v5, s[32:35], 0 offen offset:2560
    buffer_load_dword v70, v5, s[32:35], 0 offen offset:3072
    buffer_load_dword v71, v5, s[32:35], 0 offen offset:3584
    v_add_u32 v5, 16384, v5
    buffer_load_dword v72, v5, s[32:35], 0 offen offset:0
    buffer_load_dword v73, v5, s[32:35], 0 offen offset:512
    buffer_load_dword v74, v5, s[32:35], 0 offen offset:1024
    buffer_load_dword v75, v5, s[32:35], 0 offen offset:1536
    buffer_load_dword v76, v5, s[32:35], 0 offen offset:2048
    buffer_load_dword v77, v5, s[32:35], 0 offen offset:2560
    buffer_load_dword v78, v5, s[32:35], 0 offen offset:3072
    buffer_load_dword v79, v5, s[32:35], 0 offen offset:3584
    v_add_u32 v5, 16384, v5
    buffer_load_dword v80, v5, s[32:35], 0 offen offset:0
    buffer_load_dword v81, v5, s[32:35], 0 offen offset:512
    buffer_load_dword v82, v5, s[32:35], 0 offen offset:1024
    buffer_load_dword v83, v5, s[32:35], 0 offen offset:1536
    buffer_load_dword v84, v5, s[32:35], 0 offen offset:2048
    buffer_load_dword v85, v5, s[32:35], 0 offen offset:2560
    buffer_load_dword v86, v5, s[32:35], 0 offen offset:3072
    buffer_load_dword v87, v5, s[32:35], 0 offen offset:3584
    v_add_u32 v5, 16384, v5
    v_lshrrev_b32 v6, 5, v0
    v_mul_u32_u24 v6, 544, v6
    v_and_b32 v7, 31, v0
    v_lshl_add_u32 v6, v7, 4, v6
    s_mul_i32 s27, s23, 640
    s_add_u32 s27, s27, 5124096
    s_cmp_eq_u32 s22, 0
    s_cselect_b32 s43, 640, 0
    s_add_u32 s36, s20, s27
    s_addc_u32 s37, s21, 0
    s_mov_b32 s38, s43
    s_mov_b32 s39, 0x20000
    s_add_u32 s27, s26, s25
    s_add_u32 s46, s27, 4096
    s_add_u32 s28, s20, s46
    s_addc_u32 s29, s21, 0
    s_mov_b32 s30, 40512
    s_mov_b32 s31, 0x20000
    s_mov_b32 s44, 0xbfb8aa3b
    s_mov_b32 s45, 0xbfb8aa3b
    s_waitcnt vmcnt(35)
    ds_write_b128 v6, v[8:11] offset:0
    ds_write_b128 v6, v[12:15] offset:4352
    s_waitcnt vmcnt(33)
    ds_write_b128 v6, v[16:19] offset:8704
    ds_write_b128 v6, v[20:23] offset:13056
    s_waitcnt vmcnt(31)
    ds_write_b128 v6, v[24:27] offset:17408
    ds_write_b128 v6, v[28:31] offset:21760
    s_waitcnt vmcnt(29)
    ds_write_b128 v6, v[32:35] offset:26112
    ds_write_b128 v6, v[36:39] offset:30464
    s_waitcnt vmcnt(27)
    ds_write_b128 v6, v[40:43] offset:34816
    ds_write_b128 v6, v[44:47] offset:39168
    v_mul_u32_u24 v6, 544, v3
    v_lshl_add_u32 v6, v4, 4, v6
    v_lshlrev_b32 v7, 2, v3
    v_lshl_add_u32 v7, v4, 11, v7
    v_lshlrev_b32 v51, 3, v0
    s_waitcnt vmcnt(24)
    v_lshl_or_b32 v48, v49, 16, v48
    v_mov_b32 v49, v50
    s_waitcnt lgkmcnt(0)
    s_barrier
    ds_read_b128 v[8:11], v6 offset:0
    ds_read_b128 v[12:15], v6 offset:8704
    ds_read_b128 v[16:19], v6 offset:17408
    ds_read_b128 v[20:23], v6 offset:26112
    ds_read_b128 v[24:27], v6 offset:34816
    s_waitcnt vmcnt(16)
    v_perm_b32 v128, v65, v64, s40
    v_perm_b32 v129, v67, v66, s40
    v_perm_b32 v130, v69, v68, s40
    v_perm_b32 v131, v71, v70, s40
    v_perm_b32 v132, v65, v64, s41
    v_perm_b32 v133, v67, v66, s41
    v_perm_b32 v134, v69, v68, s41
    v_perm_b32 v135, v71, v70, s41
    buffer_store_dwordx2 v[48:49], v51, s[36:39], 0 offen
    s_waitcnt lgkmcnt(0)
    v_mfma_f32_16x16x32_bf16 v[144:147], v[8:11], v[128:131], 0
    ds_read_b128 v[28:31], v6 offset:64
    ds_read_b128 v[32:35], v6 offset:8768
    v_mfma_f32_16x16x32_bf16 v[148:151], v[8:11], v[132:135], 0
    ds_read_b128 v[36:39], v6 offset:17472
    ds_read_b128 v[40:43], v6 offset:26176
    v_mfma_f32_16x16x32_bf16 v[152:155], v[12:15], v[128:131], 0
    ds_read_b128 v[44:47], v6 offset:34880
    s_waitcnt vmcnt(9)
    v_mfma_f32_16x16x32_bf16 v[156:159], v[12:15], v[132:135], 0
    v_perm_b32 v136, v73, v72, s40
    v_perm_b32 v137, v75, v74, s40
    v_mfma_f32_16x16x32_bf16 v[160:163], v[16:19], v[128:131], 0
    v_perm_b32 v138, v77, v76, s40
    v_perm_b32 v139, v79, v78, s40
    v_mfma_f32_16x16x32_bf16 v[164:167], v[16:19], v[132:135], 0
    v_perm_b32 v140, v73, v72, s41
    v_perm_b32 v141, v75, v74, s41
    v_mfma_f32_16x16x32_bf16 v[168:171], v[20:23], v[128:131], 0
    v_perm_b32 v142, v77, v76, s41
    v_perm_b32 v143, v79, v78, s41
    v_mfma_f32_16x16x32_bf16 v[172:175], v[20:23], v[132:135], 0
    v_mfma_f32_16x16x32_bf16 v[176:179], v[24:27], v[128:131], 0
    v_mfma_f32_16x16x32_bf16 v[180:183], v[24:27], v[132:135], 0
    buffer_load_dword v88, v5, s[32:35], 0 offen offset:0
    buffer_load_dword v89, v5, s[32:35], 0 offen offset:512
    buffer_load_dword v90, v5, s[32:35], 0 offen offset:1024
    buffer_load_dword v91, v5, s[32:35], 0 offen offset:1536
    buffer_load_dword v92, v5, s[32:35], 0 offen offset:2048
    buffer_load_dword v93, v5, s[32:35], 0 offen offset:2560
    buffer_load_dword v94, v5, s[32:35], 0 offen offset:3072
    buffer_load_dword v95, v5, s[32:35], 0 offen offset:3584
    v_add_u32 v5, 16384, v5
    buffer_load_dword v96, v5, s[32:35], 0 offen offset:0
    buffer_load_dword v97, v5, s[32:35], 0 offen offset:512
    buffer_load_dword v98, v5, s[32:35], 0 offen offset:1024
    buffer_load_dword v99, v5, s[32:35], 0 offen offset:1536
    buffer_load_dword v100, v5, s[32:35], 0 offen offset:2048
    buffer_load_dword v101, v5, s[32:35], 0 offen offset:2560
    buffer_load_dword v102, v5, s[32:35], 0 offen offset:3072
    buffer_load_dword v103, v5, s[32:35], 0 offen offset:3584
    v_add_u32 v5, 16384, v5
    s_waitcnt lgkmcnt(0)
    v_mfma_f32_16x16x32_bf16 v[144:147], v[28:31], v[136:139], v[144:147]
    ds_read_b128 v[8:11], v6 offset:128
    ds_read_b128 v[12:15], v6 offset:8832
    v_mfma_f32_16x16x32_bf16 v[148:151], v[28:31], v[140:143], v[148:151]
    ds_read_b128 v[16:19], v6 offset:17536
    ds_read_b128 v[20:23], v6 offset:26240
    v_mfma_f32_16x16x32_bf16 v[152:155], v[32:35], v[136:139], v[152:155]
    ds_read_b128 v[24:27], v6 offset:34944
    s_waitcnt vmcnt(17)
    v_mfma_f32_16x16x32_bf16 v[156:159], v[32:35], v[140:143], v[156:159]
    v_perm_b32 v128, v81, v80, s40
    v_perm_b32 v129, v83, v82, s40
    v_mfma_f32_16x16x32_bf16 v[160:163], v[36:39], v[136:139], v[160:163]
    v_perm_b32 v130, v85, v84, s40
    v_perm_b32 v131, v87, v86, s40
    v_mfma_f32_16x16x32_bf16 v[164:167], v[36:39], v[140:143], v[164:167]
    v_perm_b32 v132, v81, v80, s41
    v_perm_b32 v133, v83, v82, s41
    v_mfma_f32_16x16x32_bf16 v[168:171], v[40:43], v[136:139], v[168:171]
    v_perm_b32 v134, v85, v84, s41
    v_perm_b32 v135, v87, v86, s41
    v_mfma_f32_16x16x32_bf16 v[172:175], v[40:43], v[140:143], v[172:175]
    v_mfma_f32_16x16x32_bf16 v[176:179], v[44:47], v[136:139], v[176:179]
    v_mfma_f32_16x16x32_bf16 v[180:183], v[44:47], v[140:143], v[180:183]
    buffer_load_dword v104, v5, s[32:35], 0 offen offset:0
    buffer_load_dword v105, v5, s[32:35], 0 offen offset:512
    buffer_load_dword v106, v5, s[32:35], 0 offen offset:1024
    buffer_load_dword v107, v5, s[32:35], 0 offen offset:1536
    buffer_load_dword v108, v5, s[32:35], 0 offen offset:2048
    buffer_load_dword v109, v5, s[32:35], 0 offen offset:2560
    buffer_load_dword v110, v5, s[32:35], 0 offen offset:3072
    buffer_load_dword v111, v5, s[32:35], 0 offen offset:3584
    v_add_u32 v5, 16384, v5
    buffer_load_dword v112, v5, s[32:35], 0 offen offset:0
    buffer_load_dword v113, v5, s[32:35], 0 offen offset:512
    buffer_load_dword v114, v5, s[32:35], 0 offen offset:1024
    buffer_load_dword v115, v5, s[32:35], 0 offen offset:1536
    buffer_load_dword v116, v5, s[32:35], 0 offen offset:2048
    buffer_load_dword v117, v5, s[32:35], 0 offen offset:2560
    buffer_load_dword v118, v5, s[32:35], 0 offen offset:3072
    buffer_load_dword v119, v5, s[32:35], 0 offen offset:3584
    v_add_u32 v5, 16384, v5
    s_waitcnt lgkmcnt(0)
    v_mfma_f32_16x16x32_bf16 v[144:147], v[8:11], v[128:131], v[144:147]
    ds_read_b128 v[28:31], v6 offset:192
    ds_read_b128 v[32:35], v6 offset:8896
    v_mfma_f32_16x16x32_bf16 v[148:151], v[8:11], v[132:135], v[148:151]
    ds_read_b128 v[36:39], v6 offset:17600
    ds_read_b128 v[40:43], v6 offset:26304
    v_mfma_f32_16x16x32_bf16 v[152:155], v[12:15], v[128:131], v[152:155]
    ds_read_b128 v[44:47], v6 offset:35008
    s_waitcnt vmcnt(24)
    v_mfma_f32_16x16x32_bf16 v[156:159], v[12:15], v[132:135], v[156:159]
    v_perm_b32 v136, v89, v88, s40
    v_perm_b32 v137, v91, v90, s40
    v_mfma_f32_16x16x32_bf16 v[160:163], v[16:19], v[128:131], v[160:163]
    v_perm_b32 v138, v93, v92, s40
    v_perm_b32 v139, v95, v94, s40
    v_mfma_f32_16x16x32_bf16 v[164:167], v[16:19], v[132:135], v[164:167]
    v_perm_b32 v140, v89, v88, s41
    v_perm_b32 v141, v91, v90, s41
    v_mfma_f32_16x16x32_bf16 v[168:171], v[20:23], v[128:131], v[168:171]
    v_perm_b32 v142, v93, v92, s41
    v_perm_b32 v143, v95, v94, s41
    v_mfma_f32_16x16x32_bf16 v[172:175], v[20:23], v[132:135], v[172:175]
    v_mfma_f32_16x16x32_bf16 v[176:179], v[24:27], v[128:131], v[176:179]
    v_mfma_f32_16x16x32_bf16 v[180:183], v[24:27], v[132:135], v[180:183]
    buffer_load_dword v120, v5, s[32:35], 0 offen offset:0
    buffer_load_dword v121, v5, s[32:35], 0 offen offset:512
    buffer_load_dword v122, v5, s[32:35], 0 offen offset:1024
    buffer_load_dword v123, v5, s[32:35], 0 offen offset:1536
    buffer_load_dword v124, v5, s[32:35], 0 offen offset:2048
    buffer_load_dword v125, v5, s[32:35], 0 offen offset:2560
    buffer_load_dword v126, v5, s[32:35], 0 offen offset:3072
    buffer_load_dword v127, v5, s[32:35], 0 offen offset:3584
    s_waitcnt lgkmcnt(0)
    v_mfma_f32_16x16x32_bf16 v[144:147], v[28:31], v[136:139], v[144:147]
    ds_read_b128 v[8:11], v6 offset:256
    ds_read_b128 v[12:15], v6 offset:8960
    v_mfma_f32_16x16x32_bf16 v[148:151], v[28:31], v[140:143], v[148:151]
    ds_read_b128 v[16:19], v6 offset:17664
    ds_read_b128 v[20:23], v6 offset:26368
    v_mfma_f32_16x16x32_bf16 v[152:155], v[32:35], v[136:139], v[152:155]
    ds_read_b128 v[24:27], v6 offset:35072
    s_waitcnt vmcnt(24)
    v_mfma_f32_16x16x32_bf16 v[156:159], v[32:35], v[140:143], v[156:159]
    v_perm_b32 v128, v97, v96, s40
    v_perm_b32 v129, v99, v98, s40
    v_mfma_f32_16x16x32_bf16 v[160:163], v[36:39], v[136:139], v[160:163]
    v_perm_b32 v130, v101, v100, s40
    v_perm_b32 v131, v103, v102, s40
    v_mfma_f32_16x16x32_bf16 v[164:167], v[36:39], v[140:143], v[164:167]
    v_perm_b32 v132, v97, v96, s41
    v_perm_b32 v133, v99, v98, s41
    v_mfma_f32_16x16x32_bf16 v[168:171], v[40:43], v[136:139], v[168:171]
    v_perm_b32 v134, v101, v100, s41
    v_perm_b32 v135, v103, v102, s41
    v_mfma_f32_16x16x32_bf16 v[172:175], v[40:43], v[140:143], v[172:175]
    v_mfma_f32_16x16x32_bf16 v[176:179], v[44:47], v[136:139], v[176:179]
    v_mfma_f32_16x16x32_bf16 v[180:183], v[44:47], v[140:143], v[180:183]
    s_waitcnt lgkmcnt(0)
    v_mfma_f32_16x16x32_bf16 v[144:147], v[8:11], v[128:131], v[144:147]
    ds_read_b128 v[28:31], v6 offset:320
    ds_read_b128 v[32:35], v6 offset:9024
    v_mfma_f32_16x16x32_bf16 v[148:151], v[8:11], v[132:135], v[148:151]
    ds_read_b128 v[36:39], v6 offset:17728
    ds_read_b128 v[40:43], v6 offset:26432
    v_mfma_f32_16x16x32_bf16 v[152:155], v[12:15], v[128:131], v[152:155]
    ds_read_b128 v[44:47], v6 offset:35136
    s_waitcnt vmcnt(16)
    v_mfma_f32_16x16x32_bf16 v[156:159], v[12:15], v[132:135], v[156:159]
    v_perm_b32 v136, v105, v104, s40
    v_perm_b32 v137, v107, v106, s40
    v_mfma_f32_16x16x32_bf16 v[160:163], v[16:19], v[128:131], v[160:163]
    v_perm_b32 v138, v109, v108, s40
    v_perm_b32 v139, v111, v110, s40
    v_mfma_f32_16x16x32_bf16 v[164:167], v[16:19], v[132:135], v[164:167]
    v_perm_b32 v140, v105, v104, s41
    v_perm_b32 v141, v107, v106, s41
    v_mfma_f32_16x16x32_bf16 v[168:171], v[20:23], v[128:131], v[168:171]
    v_perm_b32 v142, v109, v108, s41
    v_perm_b32 v143, v111, v110, s41
    v_mfma_f32_16x16x32_bf16 v[172:175], v[20:23], v[132:135], v[172:175]
    v_mfma_f32_16x16x32_bf16 v[176:179], v[24:27], v[128:131], v[176:179]
    v_mfma_f32_16x16x32_bf16 v[180:183], v[24:27], v[132:135], v[180:183]
    s_waitcnt lgkmcnt(0)
    v_mfma_f32_16x16x32_bf16 v[144:147], v[28:31], v[136:139], v[144:147]
    ds_read_b128 v[8:11], v6 offset:384
    ds_read_b128 v[12:15], v6 offset:9088
    v_mfma_f32_16x16x32_bf16 v[148:151], v[28:31], v[140:143], v[148:151]
    ds_read_b128 v[16:19], v6 offset:17792
    ds_read_b128 v[20:23], v6 offset:26496
    v_mfma_f32_16x16x32_bf16 v[152:155], v[32:35], v[136:139], v[152:155]
    ds_read_b128 v[24:27], v6 offset:35200
    s_waitcnt vmcnt(8)
    v_mfma_f32_16x16x32_bf16 v[156:159], v[32:35], v[140:143], v[156:159]
    v_perm_b32 v128, v113, v112, s40
    v_perm_b32 v129, v115, v114, s40
    v_mfma_f32_16x16x32_bf16 v[160:163], v[36:39], v[136:139], v[160:163]
    v_perm_b32 v130, v117, v116, s40
    v_perm_b32 v131, v119, v118, s40
    v_mfma_f32_16x16x32_bf16 v[164:167], v[36:39], v[140:143], v[164:167]
    v_perm_b32 v132, v113, v112, s41
    v_perm_b32 v133, v115, v114, s41
    v_mfma_f32_16x16x32_bf16 v[168:171], v[40:43], v[136:139], v[168:171]
    v_perm_b32 v134, v117, v116, s41
    v_perm_b32 v135, v119, v118, s41
    v_mfma_f32_16x16x32_bf16 v[172:175], v[40:43], v[140:143], v[172:175]
    v_mfma_f32_16x16x32_bf16 v[176:179], v[44:47], v[136:139], v[176:179]
    v_mfma_f32_16x16x32_bf16 v[180:183], v[44:47], v[140:143], v[180:183]
    s_waitcnt lgkmcnt(0)
    v_mfma_f32_16x16x32_bf16 v[144:147], v[8:11], v[128:131], v[144:147]
    ds_read_b128 v[28:31], v6 offset:448
    ds_read_b128 v[32:35], v6 offset:9152
    v_mfma_f32_16x16x32_bf16 v[148:151], v[8:11], v[132:135], v[148:151]
    ds_read_b128 v[36:39], v6 offset:17856
    ds_read_b128 v[40:43], v6 offset:26560
    v_mfma_f32_16x16x32_bf16 v[152:155], v[12:15], v[128:131], v[152:155]
    ds_read_b128 v[44:47], v6 offset:35264
    s_waitcnt vmcnt(0)
    v_mfma_f32_16x16x32_bf16 v[156:159], v[12:15], v[132:135], v[156:159]
    v_perm_b32 v136, v121, v120, s40
    v_perm_b32 v137, v123, v122, s40
    v_mfma_f32_16x16x32_bf16 v[160:163], v[16:19], v[128:131], v[160:163]
    v_perm_b32 v138, v125, v124, s40
    v_perm_b32 v139, v127, v126, s40
    v_mfma_f32_16x16x32_bf16 v[164:167], v[16:19], v[132:135], v[164:167]
    v_perm_b32 v140, v121, v120, s41
    v_perm_b32 v141, v123, v122, s41
    v_mfma_f32_16x16x32_bf16 v[168:171], v[20:23], v[128:131], v[168:171]
    v_perm_b32 v142, v125, v124, s41
    v_perm_b32 v143, v127, v126, s41
    v_mfma_f32_16x16x32_bf16 v[172:175], v[20:23], v[132:135], v[172:175]
    v_mfma_f32_16x16x32_bf16 v[176:179], v[24:27], v[128:131], v[176:179]
    v_mfma_f32_16x16x32_bf16 v[180:183], v[24:27], v[132:135], v[180:183]
    s_waitcnt lgkmcnt(0)
    v_mfma_f32_16x16x32_bf16 v[144:147], v[28:31], v[136:139], v[144:147]
    v_mfma_f32_16x16x32_bf16 v[148:151], v[28:31], v[140:143], v[148:151]
    v_mfma_f32_16x16x32_bf16 v[152:155], v[32:35], v[136:139], v[152:155]
    v_mfma_f32_16x16x32_bf16 v[156:159], v[32:35], v[140:143], v[156:159]
    v_mfma_f32_16x16x32_bf16 v[160:163], v[36:39], v[136:139], v[160:163]
    v_mfma_f32_16x16x32_bf16 v[164:167], v[36:39], v[140:143], v[164:167]
    v_mfma_f32_16x16x32_bf16 v[168:171], v[40:43], v[136:139], v[168:171]
    v_mfma_f32_16x16x32_bf16 v[172:175], v[40:43], v[140:143], v[172:175]
    v_mfma_f32_16x16x32_bf16 v[176:179], v[44:47], v[136:139], v[176:179]
    v_mfma_f32_16x16x32_bf16 v[180:183], v[44:47], v[140:143], v[180:183]
    s_nop 4
    v_pk_mul_f32 v[144:145], v[144:145], s[44:45]
    v_pk_mul_f32 v[146:147], v[146:147], s[44:45]
    v_pk_mul_f32 v[148:149], v[148:149], s[44:45]
    v_pk_mul_f32 v[150:151], v[150:151], s[44:45]
    v_cvt_pk_bf16_f32 v144, v144, v148
    v_cvt_pk_bf16_f32 v145, v145, v149
    v_cvt_pk_bf16_f32 v146, v146, v150
    v_cvt_pk_bf16_f32 v147, v147, v151
    buffer_store_dword v144, v7, s[28:31], 0 offen offset:0
    buffer_store_dword v145, v7, s[28:31], 0 offen offset:512
    buffer_store_dword v146, v7, s[28:31], 0 offen offset:1024
    buffer_store_dword v147, v7, s[28:31], 0 offen offset:1536
    v_add_u32 v7, 8192, v7
    v_pk_mul_f32 v[152:153], v[152:153], s[44:45]
    v_pk_mul_f32 v[154:155], v[154:155], s[44:45]
    v_pk_mul_f32 v[156:157], v[156:157], s[44:45]
    v_pk_mul_f32 v[158:159], v[158:159], s[44:45]
    v_cvt_pk_bf16_f32 v152, v152, v156
    v_cvt_pk_bf16_f32 v153, v153, v157
    v_cvt_pk_bf16_f32 v154, v154, v158
    v_cvt_pk_bf16_f32 v155, v155, v159
    buffer_store_dword v152, v7, s[28:31], 0 offen offset:0
    buffer_store_dword v153, v7, s[28:31], 0 offen offset:512
    buffer_store_dword v154, v7, s[28:31], 0 offen offset:1024
    buffer_store_dword v155, v7, s[28:31], 0 offen offset:1536
    v_add_u32 v7, 8192, v7
    v_pk_mul_f32 v[160:161], v[160:161], s[44:45]
    v_pk_mul_f32 v[162:163], v[162:163], s[44:45]
    v_pk_mul_f32 v[164:165], v[164:165], s[44:45]
    v_pk_mul_f32 v[166:167], v[166:167], s[44:45]
    v_cvt_pk_bf16_f32 v160, v160, v164
    v_cvt_pk_bf16_f32 v161, v161, v165
    v_cvt_pk_bf16_f32 v162, v162, v166
    v_cvt_pk_bf16_f32 v163, v163, v167
    buffer_store_dword v160, v7, s[28:31], 0 offen offset:0
    buffer_store_dword v161, v7, s[28:31], 0 offen offset:512
    buffer_store_dword v162, v7, s[28:31], 0 offen offset:1024
    buffer_store_dword v163, v7, s[28:31], 0 offen offset:1536
    v_add_u32 v7, 8192, v7
    v_pk_mul_f32 v[168:169], v[168:169], s[44:45]
    v_pk_mul_f32 v[170:171], v[170:171], s[44:45]
    v_pk_mul_f32 v[172:173], v[172:173], s[44:45]
    v_pk_mul_f32 v[174:175], v[174:175], s[44:45]
    v_cvt_pk_bf16_f32 v168, v168, v172
    v_cvt_pk_bf16_f32 v169, v169, v173
    v_cvt_pk_bf16_f32 v170, v170, v174
    v_cvt_pk_bf16_f32 v171, v171, v175
    buffer_store_dword v168, v7, s[28:31], 0 offen offset:0
    buffer_store_dword v169, v7, s[28:31], 0 offen offset:512
    buffer_store_dword v170, v7, s[28:31], 0 offen offset:1024
    buffer_store_dword v171, v7, s[28:31], 0 offen offset:1536
    v_add_u32 v7, 8192, v7
    v_pk_mul_f32 v[176:177], v[176:177], s[44:45]
    v_pk_mul_f32 v[178:179], v[178:179], s[44:45]
    v_pk_mul_f32 v[180:181], v[180:181], s[44:45]
    v_pk_mul_f32 v[182:183], v[182:183], s[44:45]
    v_cvt_pk_bf16_f32 v176, v176, v180
    v_cvt_pk_bf16_f32 v177, v177, v181
    v_cvt_pk_bf16_f32 v178, v178, v182
    v_cvt_pk_bf16_f32 v179, v179, v183
    buffer_store_dword v176, v7, s[28:31], 0 offen offset:0
    buffer_store_dword v177, v7, s[28:31], 0 offen offset:512
    buffer_store_dword v178, v7, s[28:31], 0 offen offset:1024
    buffer_store_dword v179, v7, s[28:31], 0 offen offset:1536
    v_add_u32 v7, 4294934528, v7
    s_endpgm
egnn_prep_kernel_rep:
    s_sub_u32 s23, s23, 125
    s_lshl_b32 s23, s23, 1
    s_add_u32 s23, s23, s22
    s_lshl_b32 s23, s23, 2
    s_add_u32 s23, s23, s3
    s_lshr_b32 s24, s23, 3
    s_and_b32 s25, s23, 7
    s_lshl_b32 s25, s25, 6
    s_waitcnt lgkmcnt(0)
    s_cmp_eq_u32 s24, 0
    s_cselect_b32 s26, s14, s18
    s_cselect_b32 s27, s15, s19
    s_cmp_eq_u32 s24, 2
    s_cselect_b32 s24, 131072, 0
    s_add_u32 s25, s25, s24
    s_add_u32 s32, s26, s25
    s_addc_u32 s33, s27, 0
    s_mov_b32 s34, 130624
    s_mov_b32 s35, 0x20000
    s_mov_b32 s42, 0
    buffer_load_dword v64, v5, s[32:35], 0 offen offset:0
    buffer_load_dword v65, v5, s[32:35], 0 offen offset:512
    buffer_load_dword v66, v5, s[32:35], 0 offen offset:1024
    buffer_load_dword v67, v5, s[32:35], 0 offen offset:1536
    buffer_load_dword v68, v5, s[32:35], 0 offen offset:2048
    buffer_load_dword v69, v5, s[32:35], 0 offen offset:2560
    buffer_load_dword v70, v5, s[32:35], 0 offen offset:3072
    buffer_load_dword v71, v5, s[32:35], 0 offen offset:3584
    v_add_u32 v5, 16384, v5
    buffer_load_dword v72, v5, s[32:35], 0 offen offset:0
    buffer_load_dword v73, v5, s[32:35], 0 offen offset:512
    buffer_load_dword v74, v5, s[32:35], 0 offen offset:1024
    buffer_load_dword v75, v5, s[32:35], 0 offen offset:1536
    buffer_load_dword v76, v5, s[32:35], 0 offen offset:2048
    buffer_load_dword v77, v5, s[32:35], 0 offen offset:2560
    buffer_load_dword v78, v5, s[32:35], 0 offen offset:3072
    buffer_load_dword v79, v5, s[32:35], 0 offen offset:3584
    v_add_u32 v5, 16384, v5
    buffer_load_dword v80, v5, s[32:35], 0 offen offset:0
    buffer_load_dword v81, v5, s[32:35], 0 offen offset:512
    buffer_load_dword v82, v5, s[32:35], 0 offen offset:1024
    buffer_load_dword v83, v5, s[32:35], 0 offen offset:1536
    buffer_load_dword v84, v5, s[32:35], 0 offen offset:2048
    buffer_load_dword v85, v5, s[32:35], 0 offen offset:2560
    buffer_load_dword v86, v5, s[32:35], 0 offen offset:3072
    buffer_load_dword v87, v5, s[32:35], 0 offen offset:3584
    v_add_u32 v5, 16384, v5
    buffer_load_dword v88, v5, s[32:35], 0 offen offset:0
    buffer_load_dword v89, v5, s[32:35], 0 offen offset:512
    buffer_load_dword v90, v5, s[32:35], 0 offen offset:1024
    buffer_load_dword v91, v5, s[32:35], 0 offen offset:1536
    buffer_load_dword v92, v5, s[32:35], 0 offen offset:2048
    buffer_load_dword v93, v5, s[32:35], 0 offen offset:2560
    buffer_load_dword v94, v5, s[32:35], 0 offen offset:3072
    buffer_load_dword v95, v5, s[32:35], 0 offen offset:3584
    v_add_u32 v5, 16384, v5
    buffer_load_dword v96, v5, s[32:35], 0 offen offset:0
    buffer_load_dword v97, v5, s[32:35], 0 offen offset:512
    buffer_load_dword v98, v5, s[32:35], 0 offen offset:1024
    buffer_load_dword v99, v5, s[32:35], 0 offen offset:1536
    buffer_load_dword v100, v5, s[32:35], 0 offen offset:2048
    buffer_load_dword v101, v5, s[32:35], 0 offen offset:2560
    buffer_load_dword v102, v5, s[32:35], 0 offen offset:3072
    buffer_load_dword v103, v5, s[32:35], 0 offen offset:3584
    v_add_u32 v5, 16384, v5
    buffer_load_dword v104, v5, s[32:35], 0 offen offset:0
    buffer_load_dword v105, v5, s[32:35], 0 offen offset:512
    buffer_load_dword v106, v5, s[32:35], 0 offen offset:1024
    buffer_load_dword v107, v5, s[32:35], 0 offen offset:1536
    buffer_load_dword v108, v5, s[32:35], 0 offen offset:2048
    buffer_load_dword v109, v5, s[32:35], 0 offen offset:2560
    buffer_load_dword v110, v5, s[32:35], 0 offen offset:3072
    buffer_load_dword v111, v5, s[32:35], 0 offen offset:3584
    v_add_u32 v5, 16384, v5
    buffer_load_dword v112, v5, s[32:35], 0 offen offset:0
    buffer_load_dword v113, v5, s[32:35], 0 offen offset:512
    buffer_load_dword v114, v5, s[32:35], 0 offen offset:1024
    buffer_load_dword v115, v5, s[32:35], 0 offen offset:1536
    buffer_load_dword v116, v5, s[32:35], 0 offen offset:2048
    buffer_load_dword v117, v5, s[32:35], 0 offen offset:2560
    buffer_load_dword v118, v5, s[32:35], 0 offen offset:3072
    buffer_load_dword v119, v5, s[32:35], 0 offen offset:3584
    v_add_u32 v5, 16384, v5
    buffer_load_dword v120, v5, s[32:35], 0 offen offset:0
    buffer_load_dword v121, v5, s[32:35], 0 offen offset:512
    buffer_load_dword v122, v5, s[32:35], 0 offen offset:1024
    buffer_load_dword v123, v5, s[32:35], 0 offen offset:1536
    buffer_load_dword v124, v5, s[32:35], 0 offen offset:2048
    buffer_load_dword v125, v5, s[32:35], 0 offen offset:2560
    buffer_load_dword v126, v5, s[32:35], 0 offen offset:3072
    buffer_load_dword v127, v5, s[32:35], 0 offen offset:3584
    s_add_u32 s36, s20, 3968
    s_addc_u32 s37, s21, 0
    s_mov_b32 s38, 128
    s_mov_b32 s39, 0x20000
    v_mov_b32 v7, 0
    v_lshlrev_b32 v6, 2, v2
    buffer_store_dword v7, v6, s[36:39], 0 offen
    s_lshl_b32 s27, s23, 14
    s_add_u32 s27, s27, 5373952
    s_add_u32 s28, s20, s27
    s_addc_u32 s29, s21, 0
    s_mov_b32 s30, 16384
    s_mov_b32 s31, 0x20000
    v_lshlrev_b32 v6, 4, v2
    s_mov_b32 s42, 0
    s_waitcnt vmcnt(0)
    v_perm_b32 v8, v65, v64, s40
    v_perm_b32 v12, v65, v64, s41
    v_perm_b32 v9, v67, v66, s40
    v_perm_b32 v13, v67, v66, s41
    v_perm_b32 v10, v69, v68, s40
    v_perm_b32 v14, v69, v68, s41
    v_perm_b32 v11, v71, v70, s40
    v_perm_b32 v15, v71, v70, s41
    buffer_store_dwordx4 v[8:11], v6, s[28:31], s42 offen
    buffer_store_dwordx4 v[12:15], v6, s[28:31], s42 offen offset:1024
    s_add_u32 s42, s42, 2048
    v_perm_b32 v16, v73, v72, s40
    v_perm_b32 v20, v73, v72, s41
    v_perm_b32 v17, v75, v74, s40
    v_perm_b32 v21, v75, v74, s41
    v_perm_b32 v18, v77, v76, s40
    v_perm_b32 v22, v77, v76, s41
    v_perm_b32 v19, v79, v78, s40
    v_perm_b32 v23, v79, v78, s41
    buffer_store_dwordx4 v[16:19], v6, s[28:31], s42 offen
    buffer_store_dwordx4 v[20:23], v6, s[28:31], s42 offen offset:1024
    s_add_u32 s42, s42, 2048
    v_perm_b32 v24, v81, v80, s40
    v_perm_b32 v28, v81, v80, s41
    v_perm_b32 v25, v83, v82, s40
    v_perm_b32 v29, v83, v82, s41
    v_perm_b32 v26, v85, v84, s40
    v_perm_b32 v30, v85, v84, s41
    v_perm_b32 v27, v87, v86, s40
    v_perm_b32 v31, v87, v86, s41
    buffer_store_dwordx4 v[24:27], v6, s[28:31], s42 offen
    buffer_store_dwordx4 v[28:31], v6, s[28:31], s42 offen offset:1024
    s_add_u32 s42, s42, 2048
    v_perm_b32 v32, v89, v88, s40
    v_perm_b32 v36, v89, v88, s41
    v_perm_b32 v33, v91, v90, s40
    v_perm_b32 v37, v91, v90, s41
    v_perm_b32 v34, v93, v92, s40
    v_perm_b32 v38, v93, v92, s41
    v_perm_b32 v35, v95, v94, s40
    v_perm_b32 v39, v95, v94, s41
    buffer_store_dwordx4 v[32:35], v6, s[28:31], s42 offen
    buffer_store_dwordx4 v[36:39], v6, s[28:31], s42 offen offset:1024
    s_add_u32 s42, s42, 2048
    v_perm_b32 v40, v97, v96, s40
    v_perm_b32 v44, v97, v96, s41
    v_perm_b32 v41, v99, v98, s40
    v_perm_b32 v45, v99, v98, s41
    v_perm_b32 v42, v101, v100, s40
    v_perm_b32 v46, v101, v100, s41
    v_perm_b32 v43, v103, v102, s40
    v_perm_b32 v47, v103, v102, s41
    buffer_store_dwordx4 v[40:43], v6, s[28:31], s42 offen
    buffer_store_dwordx4 v[44:47], v6, s[28:31], s42 offen offset:1024
    s_add_u32 s42, s42, 2048
    v_perm_b32 v48, v105, v104, s40
    v_perm_b32 v52, v105, v104, s41
    v_perm_b32 v49, v107, v106, s40
    v_perm_b32 v53, v107, v106, s41
    v_perm_b32 v50, v109, v108, s40
    v_perm_b32 v54, v109, v108, s41
    v_perm_b32 v51, v111, v110, s40
    v_perm_b32 v55, v111, v110, s41
    buffer_store_dwordx4 v[48:51], v6, s[28:31], s42 offen
    buffer_store_dwordx4 v[52:55], v6, s[28:31], s42 offen offset:1024
    s_add_u32 s42, s42, 2048
    v_perm_b32 v56, v113, v112, s40
    v_perm_b32 v60, v113, v112, s41
    v_perm_b32 v57, v115, v114, s40
    v_perm_b32 v61, v115, v114, s41
    v_perm_b32 v58, v117, v116, s40
    v_perm_b32 v62, v117, v116, s41
    v_perm_b32 v59, v119, v118, s40
    v_perm_b32 v63, v119, v118, s41
    buffer_store_dwordx4 v[56:59], v6, s[28:31], s42 offen
    buffer_store_dwordx4 v[60:63], v6, s[28:31], s42 offen offset:1024
    s_add_u32 s42, s42, 2048
    v_perm_b32 v128, v121, v120, s40
    v_perm_b32 v132, v121, v120, s41
    v_perm_b32 v129, v123, v122, s40
    v_perm_b32 v133, v123, v122, s41
    v_perm_b32 v130, v125, v124, s40
    v_perm_b32 v134, v125, v124, s41
    v_perm_b32 v131, v127, v126, s40
    v_perm_b32 v135, v127, v126, s41
    buffer_store_dwordx4 v[128:131], v6, s[28:31], s42 offen
    buffer_store_dwordx4 v[132:135], v6, s[28:31], s42 offen offset:1024
    s_endpgm
egnn_prep_kernel_bin:
    s_sub_u32 s22, s2, 0
    v_lshlrev_b32 v3, 2, v0
    v_lshlrev_b32 v4, 1, v0
    v_mov_b32 v5, 0
    ds_write_b32 v3, v5 offset:0
    s_mul_i32 s23, s22, 5000
    s_mul_i32 s24, s22, 2500
    s_mov_b32 s42, 4096
    s_waitcnt lgkmcnt(0)
    s_add_u32 s28, s12, s23
    s_addc_u32 s29, s13, 0
    s_mov_b32 s30, 5000
    s_mov_b32 s31, 0x20000
    s_add_u32 s32, s10, s23
    s_addc_u32 s33, s11, 0
    s_mov_b32 s34, 5000
    s_mov_b32 s35, 0x20000
    s_add_u32 s36, s8, s24
    s_addc_u32 s37, s9, 0
    s_mov_b32 s38, 2500
    s_mov_b32 s39, 0x20000
    buffer_load_dword v8, v3, s[28:31], 0 offen offset:0
    buffer_load_dword v9, v3, s[28:31], 0 offen offset:1024
    buffer_load_dword v10, v3, s[28:31], 0 offen offset:2048
    buffer_load_dword v11, v3, s[28:31], 0 offen offset:3072
    buffer_load_dword v12, v3, s[28:31], s42 offen offset:0
    buffer_load_dword v16, v3, s[32:35], 0 offen offset:0
    buffer_load_dword v17, v3, s[32:35], 0 offen offset:1024
    buffer_load_dword v18, v3, s[32:35], 0 offen offset:2048
    buffer_load_dword v19, v3, s[32:35], 0 offen offset:3072
    buffer_load_dword v20, v3, s[32:35], s42 offen offset:0
    buffer_load_ushort v24, v4, s[36:39], 0 offen offset:0
    buffer_load_ushort v25, v4, s[36:39], 0 offen offset:512
    buffer_load_ushort v26, v4, s[36:39], 0 offen offset:1024
    buffer_load_ushort v27, v4, s[36:39], 0 offen offset:1536
    buffer_load_ushort v28, v4, s[36:39], 0 offen offset:2048
    s_barrier
    s_mov_b32 s43, 214749
    s_mov_b32 s44, 625
    v_mov_b32 v6, 1
    s_mov_b32 s48, 226
    v_cmp_gt_u32 s[46:47], s48, v0
    s_waitcnt vmcnt(10)
    v_mul_u32_u24 v40, s43, v8
    v_lshrrev_b32 v40, 23, v40
    v_mad_u32_u24 v7, v40, s44, 15
    v_lshlrev_b32 v40, 2, v40
    ds_add_rtn_u32 v32, v40, v6 offset:0
    v_lshrrev_b32 v7, 4, v7
    v_sub_u32 v8, v8, v7
    v_mul_u32_u24 v41, s43, v9
    v_lshrrev_b32 v41, 23, v41
    v_mad_u32_u24 v7, v41, s44, 15
    v_lshlrev_b32 v41, 2, v41
    ds_add_rtn_u32 v33, v41, v6 offset:0
    v_lshrrev_b32 v7, 4, v7
    v_sub_u32 v9, v9, v7
    v_mul_u32_u24 v42, s43, v10
    v_lshrrev_b32 v42, 23, v42
    v_mad_u32_u24 v7, v42, s44, 15
    v_lshlrev_b32 v42, 2, v42
    ds_add_rtn_u32 v34, v42, v6 offset:0
    v_lshrrev_b32 v7, 4, v7
    v_sub_u32 v10, v10, v7
    v_mul_u32_u24 v43, s43, v11
    v_lshrrev_b32 v43, 23, v43
    v_mad_u32_u24 v7, v43, s44, 15
    v_lshlrev_b32 v43, 2, v43
    ds_add_rtn_u32 v35, v43, v6 offset:0
    v_lshrrev_b32 v7, 4, v7
    v_sub_u32 v11, v11, v7
    v_mul_u32_u24 v44, s43, v12
    v_lshrrev_b32 v44, 23, v44
    v_mad_u32_u24 v7, v44, s44, 15
    v_lshlrev_b32 v44, 2, v44
    s_mov_b64 exec, s[46:47]
    ds_add_rtn_u32 v36, v44, v6 offset:0
    v_lshrrev_b32 v7, 4, v7
    v_sub_u32 v12, v12, v7
    s_mov_b64 exec, -1
    s_waitcnt vmcnt(0)
    v_lshlrev_b32 v48, 9, v16
    v_lshl_or_b32 v49, v8, 16, v24
    v_lshlrev_b32 v50, 9, v17
    v_lshl_or_b32 v51, v9, 16, v25
    v_lshlrev_b32 v52, 9, v18
    v_lshl_or_b32 v53, v10, 16, v26
    v_lshlrev_b32 v54, 9, v19
    v_lshl_or_b32 v55, v11, 16, v27
    v_lshlrev_b32 v56, 9, v20
    v_lshl_or_b32 v57, v12, 16, v28
    v_lshlrev_b32 v7, 4, v2
    s_waitcnt lgkmcnt(0)
    s_barrier
    ds_read_b128 v[60:63], v7 offset:0
    s_lshl_b32 s25, s3, 10
    s_add_u32 s25, s25, 1024
    s_mul_i32 s26, s22, 1024
    s_add_u32 s26, s26, 5242880
    s_add_u32 s28, s20, s26
    s_addc_u32 s29, s21, 0
    s_mov_b32 s30, 1024
    s_mov_b32 s31, 0x20000
    s_mul_i32 s26, s22, 10240
    s_add_u32 s26, s26, 5767168
    s_add_u32 s32, s20, s26
    s_addc_u32 s33, s21, 0
    s_mov_b32 s34, 10000
    s_mov_b32 s35, 0x20000
    s_waitcnt lgkmcnt(0)
    v_add_u32 v65, v60, v61
    v_add_u32 v66, v65, v62
    v_add_u32 v67, v66, v63
    v_mov_b32 v68, v67
    s_nop 1
    v_add_u32_dpp v68, v68, v68 row_shr:1 row_mask:0xf bank_mask:0xf bound_ctrl:0
    s_nop 1
    v_add_u32_dpp v68, v68, v68 row_shr:2 row_mask:0xf bank_mask:0xf bound_ctrl:0
    s_nop 1
    v_add_u32_dpp v68, v68, v68 row_shr:4 row_mask:0xf bank_mask:0xf bound_ctrl:0
    s_nop 1
    v_add_u32_dpp v68, v68, v68 row_shr:8 row_mask:0xf bank_mask:0xf bound_ctrl:0
    s_nop 1
    v_add_u32_dpp v68, v68, v68 row_bcast:15 row_mask:0xa bank_mask:0xf
    s_nop 1
    v_add_u32_dpp v68, v68, v68 row_bcast:31 row_mask:0xc bank_mask:0xf
    v_sub_u32 v68, v68, v67
    v_add_u32 v69, v68, v60
    v_add_u32 v70, v68, v65
    v_add_u32 v71, v68, v66
    v_lshl_or_b32 v72, v60, 16, v68
    v_lshl_or_b32 v73, v61, 16, v69
    v_lshl_or_b32 v74, v62, 16, v70
    v_lshl_or_b32 v75, v63, 16, v71
    v_add_u32 v64, s25, v7
    ds_write_b128 v64, v[68:71]
    s_cmp_eq_u32 s3, 0
    s_cbranch_scc0 egnn_prep_kernel_nooff
    buffer_store_dwordx4 v[72:75], v7, s[28:31], 0 offen
egnn_prep_kernel_nooff:
    v_add_u32 v40, s25, v40
    v_add_u32 v41, s25, v41
    v_add_u32 v42, s25, v42
    v_add_u32 v43, s25, v43
    v_add_u32 v44, s25, v44
    s_waitcnt lgkmcnt(0)
    ds_read_b32 v40, v40
    ds_read_b32 v41, v41
    ds_read_b32 v42, v42
    ds_read_b32 v43, v43
    ds_read_b32 v44, v44
    s_waitcnt lgkmcnt(4)
    v_add_lshl_u32 v40, v40, v32, 3
    s_waitcnt lgkmcnt(3)
    v_add_lshl_u32 v41, v41, v33, 3
    s_waitcnt lgkmcnt(2)
    v_add_lshl_u32 v42, v42, v34, 3
    s_waitcnt lgkmcnt(1)
    v_add_lshl_u32 v43, v43, v35, 3
    s_waitcnt lgkmcnt(0)
    v_add_lshl_u32 v44, v44, v36, 3
    ds_write_b64 v40, v[48:49] offset:5120
    ds_write_b64 v41, v[50:51] offset:5120
    ds_write_b64 v42, v[52:53] offset:5120
    ds_write_b64 v43, v[54:55] offset:5120
    s_mov_b64 exec, s[46:47]
    ds_write_b64 v44, v[56:57] offset:5120
    s_mov_b64 exec, -1
    v_lshlrev_b32 v7, 4, v0
    s_mov_b32 s43, 8192
    s_waitcnt lgkmcnt(0)
    s_barrier
    ds_read_b128 v[8:11], v7 offset:5120
    ds_read_b128 v[12:15], v7 offset:9216
    ds_read_b128 v[16:19], v7 offset:13312
    s_waitcnt lgkmcnt(2)
    buffer_store_dwordx4 v[8:11], v7, s[32:35], 0 offen
    s_waitcnt lgkmcnt(1)
    buffer_store_dwordx4 v[12:15], v7, s[32:35], s42 offen
    s_waitcnt lgkmcnt(0)
    buffer_store_dwordx4 v[16:19], v7, s[32:35], s43 offen
egnn_prep_kernel_end:
    s_endpgm
.globl egnn_edge_kernel
.p2align 8
.type egnn_edge_kernel,@function
egnn_edge_kernel:
    s_cmp_ge_u32 s2, 256
    s_cbranch_scc1 egnn_edge_kernel_end
    s_load_dwordx2 s[22:23], s[0:1], 80
    s_load_dwordx2 s[4:5], s[0:1], 0
    s_load_dwordx4 s[12:15], s[0:1], 32
    s_load_dwordx2 s[16:17], s[0:1], 48
    s_load_dwordx2 s[20:21], s[0:1], 64
    s_and_b32 s3, s2, 7
    s_lshl_b32 s3, s3, 5
    s_lshr_b32 s44, s2, 3
    s_add_u32 s44, s44, s3
    v_lshrrev_b32 v13, 6, v0
    v_and_b32 v14, 63, v0
    v_readfirstlane_b32 s47, v13
    v_lshrrev_b32 v16, 2, v0
    s_lshl_b32 s3, s44, 2
    v_lshl_add_u32 v17, v16, 10, s3
    s_mul_i32 s3, s44, 625
    s_add_u32 s45, s3, 15
    s_lshr_b32 s45, s45, 4
    s_add_u32 s3, s3, 640
    s_lshr_b32 s3, s3, 4
    s_sub_u32 s46, s3, s45
    s_and_b32 s48, s47, 3
    s_lshr_b32 s49, s47, 2
    s_lshl_b32 s50, s48, 7
    v_lshlrev_b32 v19, 4, v0
    v_lshlrev_b32 v13, 4, v14
    v_mov_b32 v24, 0
    v_mov_b32 v25, 0
    v_mov_b32 v26, 0
    v_mov_b32 v27, 0
    v_add_u32 v29, 28928, v19
    ds_write_b128 v29, v[24:27] offset:49152
    s_waitcnt lgkmcnt(0)
    s_add_u32 s28, s22, 5242880
    s_addc_u32 s29, s23, 0
    s_mov_b32 s30, 131072
    s_mov_b32 s31, 0x20000
    buffer_load_dword v18, v17, s[28:31], 0 offen
    s_lshl_b32 s3, s47, 14
    s_add_u32 s3, s3, 5373952
    s_add_u32 s36, s22, s3
    s_addc_u32 s37, s23, 0
    s_mov_b32 s38, 278528
    s_mov_b32 s39, 0x20000
    s_barrier
    s_mov_b32 s3, 0
    buffer_load_dwordx4 a[0:3], v13, s[36:39], s3 offen offset:0
    buffer_load_dwordx4 a[4:7], v13, s[36:39], s3 offen offset:1024
    buffer_load_dwordx4 a[8:11], v13, s[36:39], s3 offen offset:2048
    buffer_load_dwordx4 a[12:15], v13, s[36:39], s3 offen offset:3072
    ds_write_b128 v29, v[24:27] offset:0
    ds_write_b128 v29, v[24:27] offset:8192
    ds_write_b128 v29, v[24:27] offset:16384
    s_add_u32 s32, s22, 5767168
    s_addc_u32 s33, s23, 0
    s_mov_b32 s34, 1310720
    s_mov_b32 s35, 0x20000
    s_lshl_b32 s3, s45, 9
    s_lshl_b32 s78, s46, 9
    s_add_u32 s28, s4, s3
    s_addc_u32 s29, s5, 0
    s_mov_b32 s30, s78
    s_mov_b32 s31, 0x20000
    v_mul_u32_u24 v16, 10240, v16
    v_and_b32 v17, 3, v0
    s_mov_b32 s78, 8192
    s_mov_b32 s79, 16384
    s_waitcnt vmcnt(4)
    v_and_b32 v34, 0xffff, v18
    v_lshrrev_b32 v35, 16, v18
    v_add_u32 v34, v34, v17
    v_lshl_add_u32 v16, v34, 3, v16
    buffer_load_dwordx2 v[36:37], v16, s[32:35], 0 offen offset:0
    buffer_load_dwordx2 v[38:39], v16, s[32:35], 0 offen offset:32
    buffer_load_dwordx2 v[40:41], v16, s[32:35], 0 offen offset:64
    s_barrier
    buffer_load_dwordx4 v[112:115], v19, s[28:31], 0 offen
    buffer_load_dwordx4 v[116:119], v19, s[28:31], s78 offen
    buffer_load_dwordx4 v[120:123], v19, s[28:31], s79 offen
    s_add_u32 s40, s22, 5124096
    s_addc_u32 s41, s23, 0
    s_mov_b32 s42, 80000
    s_mov_b32 s43, 0x20000
    s_lshl_b32 s3, s45, 3
    v_lshlrev_b32 v20, 3, v0
    v_add_u32 v21, s3, v20
    s_cmp_eq_u32 s47, 0
    s_cselect_b32 s42, 80000, 0
    buffer_load_dwordx2 v[124:125], v21, s[40:43], 0 offen
    s_cselect_b32 s78, 512, 0
    s_mov_b32 s42, 80000
    s_mov_b32 s28, s16
    s_mov_b32 s29, s17
    s_mov_b32 s30, s78
    s_mov_b32 s31, 0x20000
    buffer_load_dwordx2 v[126:127], v20, s[28:31], 0 offen
    s_add_u32 s3, s50, 262144
    s_add_u32 s28, s14, s3
    s_addc_u32 s29, s15, 0
    s_mov_b32 s30, 640
    s_mov_b32 s31, 0x20000
    v_and_b32 v22, 31, v0
    v_lshlrev_b32 v22, 2, v22
    buffer_load_dword v128, v22, s[28:31], 0 offen
    buffer_load_dword v129, v22, s[28:31], 0 offen offset:512
    s_mov_b32 s3, 4096
    buffer_load_dwordx4 a[16:19], v13, s[36:39], s3 offen offset:0
    buffer_load_dwordx4 a[20:23], v13, s[36:39], s3 offen offset:1024
    buffer_load_dwordx4 a[24:27], v13, s[36:39], s3 offen offset:2048
    ds_write_b128 v29, v[24:27] offset:24576
    ds_write_b128 v29, v[24:27] offset:32768
    ds_write_b128 v29, v[24:27] offset:40960
    v_cmp_eq_u32 s[90:91], 0, v17
    s_mov_b32 s81, 0
    s_mov_b32 s82, 0
    s_mov_b32 s65, 0
    s_mov_b32 s55, 0
    s_mov_b32 s80, 192
    v_add_u32 v34, 0, v17
    v_cmp_lt_u32 s[68:69], v34, v35
    v_add_u32 v34, 4, v17
    v_cmp_lt_u32 s[70:71], v34, v35
    v_add_u32 v34, 8, v17
    v_cmp_lt_u32 s[72:73], v34, v35
    v_mov_b32 v33, 83968
    v_mov_b32 v34, 1
    s_waitcnt vmcnt(10)
    v_lshrrev_b32 v42, 19, v37
    v_lshl_add_u32 v45, v42, 2, v33
    v_lshrrev_b32 v43, 19, v39
    v_lshl_add_u32 v46, v43, 2, v33
    v_lshrrev_b32 v44, 19, v41
    v_lshl_add_u32 v47, v44, 2, v33
    s_mov_b64 exec, s[68:69]
    ds_add_rtn_u32 v45, v45, v34
    s_mov_b64 exec, s[70:71]
    ds_add_rtn_u32 v46, v46, v34
    s_mov_b64 exec, s[72:73]
    ds_add_rtn_u32 v47, v47, v34
    s_mov_b64 exec, -1
    s_waitcnt lgkmcnt(0)
    v_cmp_gt_u32 vcc, s80, v45
    v_mad_u32_u24 v42, v42, s80, v45
    v_lshlrev_b32 v42, 3, v42
    s_and_b64 exec, vcc, s[68:69]
    ds_write_b64 v42, v[36:37] offset:1088
    s_mov_b64 exec, -1
    v_cmp_gt_u32 vcc, s80, v46
    v_mad_u32_u24 v43, v43, s80, v46
    v_lshlrev_b32 v43, 3, v43
    s_and_b64 exec, vcc, s[70:71]
    ds_write_b64 v43, v[38:39] offset:1088
    s_mov_b64 exec, -1
    v_cmp_gt_u32 vcc, s80, v47
    v_mad_u32_u24 v44, v44, s80, v47
    v_lshlrev_b32 v44, 3, v44
    s_and_b64 exec, vcc, s[72:73]
    ds_write_b64 v44, v[40:41] offset:1088
    s_mov_b64 exec, -1
    s_mov_b64 exec, -1
    v_add_u32 v48, 12, v17
    v_add_u32 v49, 96, v16
egnn_edge_kernel_more:
    v_cmp_lt_u32 s[68:69], v48, v35
    s_cmp_eq_u64 s[68:69], 0
    s_cbranch_scc1 egnn_edge_kernel_more_done
    buffer_load_dwordx2 v[36:37], v49, s[32:35], 0 offen
    v_add_u32 v48, 4, v48
    v_add_u32 v49, 32, v49
    s_waitcnt vmcnt(0)
    v_lshrrev_b32 v42, 19, v37
    v_lshl_add_u32 v45, v42, 2, v33
    s_mov_b64 exec, s[68:69]
    ds_add_rtn_u32 v45, v45, v34
    s_mov_b64 exec, -1
    s_waitcnt lgkmcnt(0)
    v_cmp_gt_u32 vcc, s80, v45
    v_mad_u32_u24 v42, v42, s80, v45
    v_lshlrev_b32 v42, 3, v42
    s_and_b64 exec, vcc, s[68:69]
    ds_write_b64 v42, v[36:37] offset:1088
    s_mov_b64 exec, -1
    s_mov_b64 exec, -1
    s_branch egnn_edge_kernel_more
egnn_edge_kernel_more_done:
    s_waitcnt lgkmcnt(0)
    s_barrier
    ds_read_b128 v[36:39], v33
    ds_read_b32 v40, v33 offset:16
    v_lshrrev_b32 v30, 5, v0
    v_mul_u32_u24 v30, 544, v30
    v_lshl_add_u32 v30, v22, 2, v30
    v_add_u32 v30, 106432, v30
    s_waitcnt vmcnt(3)
    ds_write_b128 v30, v[112:115]
    ds_write_b128 v30, v[116:119] offset:8704
    s_cmp_lt_u32 s47, 4
    s_cbranch_scc0 egnn_edge_kernel_hi4
    ds_write_b128 v30, v[120:123] offset:17408
    s_cmp_eq_u32 s47, 0
    s_cbranch_scc0 egnn_edge_kernel_hi4
    ds_write_b64 v20, v[126:127] offset:576
    s_mov_b32 exec_hi, 0xff
    ds_write_b64 v20, v[124:125] offset:256
    s_mov_b32 exec_hi, -1
egnn_edge_kernel_hi4:
    s_waitcnt lgkmcnt(2)
    v_readfirstlane_b32 s6, v36
    v_readfirstlane_b32 s7, v37
    v_readfirstlane_b32 s8, v38
    v_readfirstlane_b32 s9, v39
    v_readfirstlane_b32 s10, v40
    s_nop 0
    s_max_u32 s3, s6, s7
    s_max_u32 s3, s3, s8
    s_max_u32 s3, s3, s9
    s_max_u32 s3, s3, s10
    s_cmp_gt_u32 s3, 192
    s_cbranch_scc1 egnn_edge_kernel_slowprep
egnn_edge_kernel_build:
    s_add_u32 s78, s47, 0
    s_lshl_b32 s3, s78, 9
    v_lshl_add_u32 v36, v14, 3, s3
    ds_read_b64 v[38:39], v36 offset:1088
    s_add_u32 s78, s47, 8
    s_lshl_b32 s3, s78, 9
    v_lshl_add_u32 v64, v14, 3, s3
    ds_read_b64 v[66:67], v64 offset:1088
    s_add_u32 s3, s6, 15
    s_lshr_b32 s3, s3, 4
    s_max_u32 s3, s3, 1
    s_add_u32 s56, s55, s3
    s_add_u32 s3, s7, 15
    s_lshr_b32 s3, s3, 4
    s_max_u32 s3, s3, 1
    s_add_u32 s57, s56, s3
    s_add_u32 s3, s8, 15
    s_lshr_b32 s3, s3, 4
    s_max_u32 s3, s3, 1
    s_add_u32 s58, s57, s3
    s_add_u32 s3, s9, 15
    s_lshr_b32 s3, s3, 4
    s_max_u32 s3, s3, 1
    s_add_u32 s59, s58, s3
    s_add_u32 s3, s10, 15
    s_lshr_b32 s3, s3, 4
    s_max_u32 s3, s3, 1
    s_add_u32 s60, s59, s3
    s_cmp_gt_u32 s60, 50
    s_cbranch_scc1 egnn_edge_kernel_slowprep
    s_add_u32 s100, s60, 1
    s_lshr_b32 s100, s100, 1
    v_lshrrev_b32 v33, 4, v14
    s_add_u32 s78, s47, 0
    s_mul_i32 s79, s78, 43
    s_lshr_b32 s79, s79, 7
    s_min_u32 m0, s79, 4
    s_mul_i32 s3, s79, 3
    s_movrels_b32 s92, s6
    s_movrels_b32 s93, s55
    s_movrels_b32 s80, s56
    s_sub_u32 s3, s78, s3
    s_lshl_b32 s3, s3, 2
    s_add_u32 s93, s93, s3
    s_lshl_b32 s3, s3, 4
    v_add_u32 v36, s3, v14
    v_cmp_gt_u32 s[68:69], s92, v36
    v_add_u32 v37, s93, v33
    v_cmp_gt_u32 s[16:17], s80, v37
    s_waitcnt lgkmcnt(1)
    v_cndmask_b32 v38, 0, v38, s[68:69]
    v_cndmask_b32 v39, 0, v39, s[68:69]
    v_lshrrev_b32 v36, 6, v38
    buffer_load_dwordx2 v[40:41], v36, s[40:43], 0 offen
    s_add_u32 s78, s47, 8
    s_mul_i32 s79, s78, 43
    s_lshr_b32 s79, s79, 7
    s_min_u32 m0, s79, 4
    s_mul_i32 s3, s79, 3
    s_movrels_b32 s94, s6
    s_movrels_b32 s95, s55
    s_movrels_b32 s80, s56
    s_sub_u32 s3, s78, s3
    s_lshl_b32 s3, s3, 2
    s_add_u32 s95, s95, s3
    s_lshl_b32 s3, s3, 4
    s_cmp_eq_u32 s79, 5
    s_cselect_b32 s94, 0, s94
    s_cselect_b32 s80, 0, s80
    v_add_u32 v64, s3, v14
    v_cmp_gt_u32 s[70:71], s94, v64
    v_add_u32 v65, s95, v33
    v_cmp_gt_u32 s[18:19], s80, v65
    s_waitcnt lgkmcnt(0)
    v_cndmask_b32 v66, 0, v66, s[70:71]
    v_cndmask_b32 v67, 0, v67, s[70:71]
    v_lshrrev_b32 v64, 6, v66
    buffer_load_dwordx2 v[68:69], v64, s[40:43], 0 offen
    v_bfe_u32 v30, v14, 3, 1
    v_lshlrev_b32 v31, 7, v30
    v_sub_u32 v31, 128, v31
    s_mov_b32 s80, 320
    v_cmp_le_u32 s[72:73], s100, v37
    s_lshl_b32 s3, s93, 6
    s_add_u32 s3, s3, 28928
    v_lshl_add_u32 v36, v14, 2, s3
    v_add_u32 v37, s80, v36
    v_cndmask_b32 v36, v36, v37, s[72:73]
    v_add_u32 v38, v31, v38
    s_mov_b64 exec, s[68:69]
    ds_write_b32 v36, v38
    s_mov_b64 exec, -1
    v_cmp_le_u32 s[72:73], s100, v65
    s_lshl_b32 s3, s95, 6
    s_add_u32 s3, s3, 28928
    v_lshl_add_u32 v64, v14, 2, s3
    v_add_u32 v65, s80, v64
    v_cndmask_b32 v64, v64, v65, s[72:73]
    v_add_u32 v66, v31, v66
    s_mov_b64 exec, s[70:71]
    ds_write_b32 v64, v66
    s_mov_b64 exec, -1
    s_cmp_eq_u32 s49, 0
    s_cselect_b32 s66, 0, s100
    s_cselect_b32 s62, s100, s60
    s_cselect_b32 s78, 0, 5
    s_mov_b32 s64, 0
    s_cmp_le_u32 s56, s66
    s_addc_u32 s64, s64, 0
    s_cmp_le_u32 s57, s66
    s_addc_u32 s64, s64, 0
    s_cmp_le_u32 s58, s66
    s_addc_u32 s64, s64, 0
    s_cmp_le_u32 s59, s66
    s_addc_u32 s64, s64, 0
    s_mov_b32 m0, s64
    s_mov_b32 s11, s64
    s_movrels_b32 s3, s56
    s_sub_u32 s54, s3, 1
    s_add_u32 s51, s3, 1
    s_min_u32 s63, s51, s62
    s_mov_b32 s61, s66
    s_mov_b32 s98, s49
    s_add_u32 s3, s66, s78
    s_lshl_b32 s3, s3, 6
    s_add_u32 s3, s3, 28928
    v_lshrrev_b32 v4, 5, v14
    v_lshl_add_u32 v4, v4, 5, s3
    s_waitcnt lgkmcnt(0)
    s_barrier
    v_lshrrev_b32 v37, 13, v39
    v_and_b32 v37, 0x1f8, v37
    ds_read_b64 v[42:43], v37 offset:256
    v_lshrrev_b32 v65, 13, v67
    v_and_b32 v65, 0x1f8, v65
    ds_read_b64 v[70:71], v65 offset:256
    s_cmp_eq_u32 s81, 2
    s_cbranch_scc1 egnn_edge_kernel_noA0
    s_mov_b32 s3, 4096
    buffer_load_dwordx4 a[28:31], v13, s[36:39], s3 offen offset:3072
    s_mov_b32 s3, 8192
    buffer_load_dwordx4 a[32:35], v13, s[36:39], s3 offen offset:0
    buffer_load_dwordx4 a[36:39], v13, s[36:39], s3 offen offset:1024
    v_lshrrev_b32 v26, 2, v14
    v_add_u32 v26, -1, v26
    v_lshrrev_b32 v27, 1, v26
    v_cmp_eq_u32 s[78:79], v27, v17
    v_and_b32 v26, 1, v26
    v_lshlrev_b32 v26, 4, v26
    v_mov_b32 v28, 0x3f80
    v_lshlrev_b32 v26, v26, v28
    v_cndmask_b32 v26, 0, v26, s[78:79]
    v_lshlrev_b32 v27, 2, v14
    ds_write_b32 v27, v26 offset:0
    v_cmp_gt_u32 s[78:79], 2, v17
    v_and_b32 v26, 1, v14
    v_lshlrev_b32 v26, 4, v26
    v_lshlrev_b32 v26, v26, v28
    v_cndmask_b32 v144, 0, v26, s[78:79]
    v_cndmask_b32 v145, v26, 0, s[78:79]
    v_mov_b32 v10, 0
    v_mov_b32 v11, 0
    v_lshrrev_b32 v27, 5, v14
    v_bfe_u32 v26, v14, 2, 3
    v_mul_u32_u24 v26, 544, v26
    v_lshl_add_u32 v26, v27, 4, v26
    s_add_u32 s3, s50, 84672
    v_add_u32 v146, s3, v26
    s_mul_i32 s3, s47, 640
    s_add_u32 s3, s3, 1088
    v_add_u32 v147, s3, v22
    s_add_u32 s3, s50, 576
    v_lshl_add_u32 v9, v27, 4, s3
    v_and_b32 v26, 15, v14
    v_bfe_u32 v27, v14, 4, 1
    v_cmp_eq_u32 s[78:79], v26, v27
    v_mov_b32 v27, 144
    s_nop 0
    v_cndmask_b32 v9, v27, v9, s[78:79]
    v_mul_u32_u24 v26, 544, v26
    v_lshl_add_u32 v12, v33, 4, v26
    s_add_u32 s3, s50, 3968
    s_add_u32 s24, s22, s3
    s_addc_u32 s25, s23, 0
    s_or_b32 s25, s25, 0x40000
    s_mov_b32 s26, 64
    s_mov_b32 s27, 0x00800000
    s_mov_b32 s76, 0xbfb8aa3b
    s_mov_b32 s77, 0xbfb8aa3b
    v_cmp_gt_u32 s[78:79], 32, v14
    v_lshlrev_b32 v130, 16, v128
    v_and_b32 v131, 0xffff0000, v128
    v_pk_mul_f32 v[130:131], v[130:131], s[76:77]
    v_cvt_pk_bf16_f32 v132, v130, v131
    v_lshlrev_b32 v134, 16, v132
    v_and_b32 v135, 0xffff0000, v132
    v_pk_add_f32 v[130:131], v[130:131], v[134:135] neg_lo:[0,1] neg_hi:[0,1]
    v_cvt_pk_bf16_f32 v133, v130, v131
    v_cndmask_b32 v166, v133, v132, s[78:79]
    v_lshlrev_b32 v130, 16, v129
    v_and_b32 v131, 0xffff0000, v129
    v_pk_mul_f32 v[130:131], v[130:131], s[76:77]
    v_cvt_pk_bf16_f32 v132, v130, v131
    v_lshlrev_b32 v134, 16, v132
    v_and_b32 v135, 0xffff0000, v132
    v_pk_add_f32 v[130:131], v[130:131], v[134:135] neg_lo:[0,1] neg_hi:[0,1]
    v_cvt_pk_bf16_f32 v133, v130, v131
    v_cndmask_b32 v167, v133, v132, s[78:79]
    s_waitcnt vmcnt(5)
    v_add_u32 v31, 106432, v12
    ds_read_b128 v[80:83], v31 offset:0
    ds_read_b128 v[84:87], v31 offset:8704
    ds_read_b128 v[88:91], v31 offset:17408
    ds_read_b128 v[92:95], v31 offset:64
    ds_read_b128 v[96:99], v31 offset:8768
    ds_read_b128 v[100:103], v31 offset:17472
    ds_read_b128 v[104:107], v31 offset:128
    ds_read_b128 v[108:111], v31 offset:8832
    s_waitcnt lgkmcnt(7)
    v_mfma_f32_16x16x32_bf16 v[168:171], v[80:83], a[0:3], 0
    v_mfma_f32_16x16x32_bf16 v[172:175], v[80:83], a[4:7], 0
    ds_read_b128 v[80:83], v31 offset:17536
    s_waitcnt lgkmcnt(7)
    v_mfma_f32_16x16x32_bf16 v[176:179], v[84:87], a[0:3], 0
    v_mfma_f32_16x16x32_bf16 v[180:183], v[84:87], a[4:7], 0
    s_waitcnt lgkmcnt(6)
    v_mfma_f32_16x16x32_bf16 v[184:187], v[88:91], a[0:3], 0
    v_mfma_f32_16x16x32_bf16 v[188:191], v[88:91], a[4:7], 0
    s_waitcnt lgkmcnt(5)
    v_mfma_f32_16x16x32_bf16 v[168:171], v[92:95], a[8:11], v[168:171]
    v_mfma_f32_16x16x32_bf16 v[172:175], v[92:95], a[12:15], v[172:175]
    s_waitcnt lgkmcnt(4)
    v_mfma_f32_16x16x32_bf16 v[176:179], v[96:99], a[8:11], v[176:179]
    v_mfma_f32_16x16x32_bf16 v[180:183], v[96:99], a[12:15], v[180:183]
    s_waitcnt lgkmcnt(3)
    v_mfma_f32_16x16x32_bf16 v[184:187], v[100:103], a[8:11], v[184:187]
    v_mfma_f32_16x16x32_bf16 v[188:191], v[100:103], a[12:15], v[188:191]
    s_waitcnt lgkmcnt(2)
    v_mfma_f32_16x16x32_bf16 v[168:171], v[104:107], a[16:19], v[168:171]
    v_mfma_f32_16x16x32_bf16 v[172:175], v[104:107], a[20:23], v[172:175]
    s_waitcnt lgkmcnt(1)
    v_mfma_f32_16x16x32_bf16 v[176:179], v[108:111], a[16:19], v[176:179]
    v_mfma_f32_16x16x32_bf16 v[180:183], v[108:111], a[20:23], v[180:183]
    s_waitcnt lgkmcnt(0)
    v_mfma_f32_16x16x32_bf16 v[184:187], v[80:83], a[16:19], v[184:187]
    v_mfma_f32_16x16x32_bf16 v[188:191], v[80:83], a[20:23], v[188:191]
    s_waitcnt vmcnt(3)
    s_mov_b32 s3, 8192
    buffer_load_dwordx4 a[40:43], v13, s[36:39], s3 offen offset:2048
    buffer_load_dwordx4 a[44:47], v13, s[36:39], s3 offen offset:3072
    s_mov_b32 s3, 12288
    buffer_load_dwordx4 a[48:51], v13, s[36:39], s3 offen offset:0
    buffer_load_dwordx4 a[52:55], v13, s[36:39], s3 offen offset:1024
    buffer_load_dwordx4 a[56:59], v13, s[36:39], s3 offen offset:2048
    buffer_load_dwordx4 a[60:63], v13, s[36:39], s3 offen offset:3072
    s_branch egnn_edge_kernel_geo
egnn_edge_kernel_noA0:
    s_waitcnt vmcnt(0)
egnn_edge_kernel_geo:
    ds_read_b128 v[112:115], v4 offset:0
    ds_read_b128 v[116:119], v4 offset:16
    ds_read_b128 v[120:123], v4 offset:64
    ds_read_b128 v[124:127], v4 offset:80
    v_lshlrev_b32 v32, 10, v33
    v_lshl_add_u32 v32, v30, 9, v32
    v_and_b32 v33, 7, v14
    v_lshl_add_u32 v32, v33, 1, v32
    s_mov_b32 s78, 0x00200020
    s_mov_b64 exec, s[16:17]
    s_cbranch_execz egnn_edge_kernel_geo_done0
    v_lshlrev_b32 v44, 16, v42
    v_and_b32 v45, 0xffff0000, v42
    v_lshlrev_b32 v46, 16, v40
    v_and_b32 v47, 0xffff0000, v40
    v_lshlrev_b32 v48, 16, v43
    v_lshlrev_b32 v49, 16, v41
    v_pk_add_f32 v[44:45], v[44:45], v[46:47] neg_lo:[0,1] neg_hi:[0,1]
    v_sub_f32 v48, v48, v49
    v_cvt_pk_bf16_f32 v40, v44, v45
    v_cvt_pk_bf16_f32 v41, v48, 1.0
    v_bfe_u32 v53, v39, 16, 3
    v_lshl_add_u32 v53, v53, 6, v32
    s_lshl_b32 s3, s93, 10
    s_add_u32 s3, s3, 32768
    v_add_u32 v53, s3, v53
    s_mov_b64 exec, s[68:69]
    ds_write_b16_d16_hi v53, v41
    ds_write_b16 v53, v40 offset:16
    ds_write_b16_d16_hi v53, v40 offset:32
    ds_write_b16 v53, v41 offset:48
    s_mov_b64 exec, s[16:17]
    v_lshlrev_b32 v44, 16, v40
    v_and_b32 v45, 0xffff0000, v40
    v_lshlrev_b32 v46, 16, v41
    v_pk_mul_f32 v[44:45], v[44:45], v[44:45]
    v_mul_f32 v46, v46, v46
    v_cvt_pk_bf16_f32 v44, v44, v45
    v_cvt_pk_bf16_f32 v46, 0, v46
    v_lshlrev_b32 v45, 16, v44
    v_and_b32 v44, 0xffff0000, v44
    v_add_f32 v44, v45, v44
    v_add_f32 v44, v44, v46
    v_cvt_pk_bf16_f32 v44, v44, 0
    v_and_b32 v45, 0xffff, v39
    v_lshlrev_b32 v46, 16, v44
    v_lshlrev_b32 v47, 16, v39
    s_lshl_b32 s3, s93, 8
    s_add_u32 s3, s3, 8960
    v_lshl_add_u32 v48, v14, 4, s3
    ds_write_b128 v48, v[44:47]
    v_bfe_u32 v50, v39, 16, 2
    v_bfe_u32 v51, v39, 18, 1
    v_cmp_eq_u32 vcc, 0, v51
    v_mul_u32_u24 v50, s78, v50
    v_add_u32 v50, 0x00200010, v50
    v_cndmask_b32_e64 v51, v50, 0, vcc
    v_cndmask_b32_e64 v50, 0, v50, vcc
    s_lshl_b32 s3, s93, 7
    s_add_u32 s3, s3, 22272
    v_lshl_add_u32 v52, v14, 3, s3
    ds_write_b64 v52, v[50:51]
egnn_edge_kernel_geo_done0:
    s_mov_b64 exec, s[18:19]
    s_cbranch_execz egnn_edge_kernel_geo_done1
    v_lshlrev_b32 v72, 16, v70
    v_and_b32 v73, 0xffff0000, v70
    v_lshlrev_b32 v74, 16, v68
    v_and_b32 v75, 0xffff0000, v68
    v_lshlrev_b32 v76, 16, v71
    v_lshlrev_b32 v77, 16, v69
    v_pk_add_f32 v[72:73], v[72:73], v[74:75] neg_lo:[0,1] neg_hi:[0,1]
    v_sub_f32 v76, v76, v77
    v_cvt_pk_bf16_f32 v68, v72, v73
    v_cvt_pk_bf16_f32 v69, v76, 1.0
    v_bfe_u32 v81, v67, 16, 3
    v_lshl_add_u32 v81, v81, 6, v32
    s_lshl_b32 s3, s95, 10
    s_add_u32 s3, s3, 32768
    v_add_u32 v81, s3, v81
    s_mov_b64 exec, s[70:71]
    ds_write_b16_d16_hi v81, v69
    ds_write_b16 v81, v68 offset:16
    ds_write_b16_d16_hi v81, v68 offset:32
    ds_write_b16 v81, v69 offset:48
    s_mov_b64 exec, s[18:19]
    v_lshlrev_b32 v72, 16, v68
    v_and_b32 v73, 0xffff0000, v68
    v_lshlrev_b32 v74, 16, v69
    v_pk_mul_f32 v[72:73], v[72:73], v[72:73]
    v_mul_f32 v74, v74, v74
    v_cvt_pk_bf16_f32 v72, v72, v73
    v_cvt_pk_bf16_f32 v74, 0, v74
    v_lshlrev_b32 v73, 16, v72
    v_and_b32 v72, 0xffff0000, v72
    v_add_f32 v72, v73, v72
    v_add_f32 v72, v72, v74
    v_cvt_pk_bf16_f32 v72, v72, 0
    v_and_b32 v73, 0xffff, v67
    v_lshlrev_b32 v74, 16, v72
    v_lshlrev_b32 v75, 16, v67
    s_lshl_b32 s3, s95, 8
    s_add_u32 s3, s3, 8960
    v_lshl_add_u32 v76, v14, 4, s3
    ds_write_b128 v76, v[72:75]
    v_bfe_u32 v78, v67, 16, 2
    v_bfe_u32 v79, v67, 18, 1
    v_cmp_eq_u32 vcc, 0, v79
    v_mul_u32_u24 v78, s78, v78
    v_add_u32 v78, 0x00200010, v78
    v_cndmask_b32_e64 v79, v78, 0, vcc
    v_cndmask_b32_e64 v78, 0, v78, vcc
    s_lshl_b32 s3, s95, 7
    s_add_u32 s3, s3, 22272
    v_lshl_add_u32 v80, v14, 3, s3
    ds_write_b64 v80, v[78:79]
egnn_edge_kernel_geo_done1:
    s_mov_b64 exec, -1
    s_lshl_b32 s3, s66, 10
    s_add_u32 s3, s3, 32768
    v_add_u32 v1, s3, v13
    s_lshl_b32 s3, s64, 2
    s_add_u32 s3, s3, s48
    s_lshl_b32 s3, s3, 10
    s_add_u32 s3, s3, 128192
    v_add_u32 v6, s3, v13
    v_bfe_u32 v26, v14, 1, 1
    v_bfe_u32 v27, v14, 3, 2
    v_lshl_add_u32 v26, v27, 1, v26
    v_bfe_u32 v27, v14, 2, 1
    v_lshl_add_u32 v26, v27, 3, v26
    v_and_b32 v27, 1, v14
    v_lshl_add_u32 v28, v26, 1, v27
    s_lshl_b32 s3, s66, 8
    s_add_u32 s3, s3, 8960
    v_lshl_add_u32 v2, v28, 3, s3
    v_lshrrev_b32 v28, 5, v14
    v_lshl_add_u32 v27, v28, 1, v27
    v_lshl_add_u32 v27, v26, 2, v27
    s_lshl_b32 s3, s66, 7
    s_add_u32 s3, s3, 22272
    v_lshl_add_u32 v3, v27, 1, s3
    s_waitcnt lgkmcnt(0)
    buffer_load_dword v112, v112, s[24:27], 0 offen
    buffer_load_dword v113, v113, s[24:27], 0 offen
    buffer_load_dword v114, v114, s[24:27], 0 offen
    buffer_load_dword v115, v115, s[24:27], 0 offen
    buffer_load_dword v116, v116, s[24:27], 0 offen
    buffer_load_dword v117, v117, s[24:27], 0 offen
    buffer_load_dword v118, v118, s[24:27], 0 offen
    buffer_load_dword v119, v119, s[24:27], 0 offen
    buffer_load_dword v120, v120, s[24:27], 0 offen
    buffer_load_dword v121, v121, s[24:27], 0 offen
    buffer_load_dword v122, v122, s[24:27], 0 offen
    buffer_load_dword v123, v123, s[24:27], 0 offen
    buffer_load_dword v124, v124, s[24:27], 0 offen
    buffer_load_dword v125, v125, s[24:27], 0 offen
    buffer_load_dword v126, v126, s[24:27], 0 offen
    buffer_load_dword v127, v127, s[24:27], 0 offen
    s_cmp_eq_u32 s81, 2
    s_cbranch_scc1 egnn_edge_kernel_noA
    v_add_u32 v31, 106432, v12
    ds_read_b128 v[80:83], v31 offset:192
    ds_read_b128 v[84:87], v31 offset:8896
    ds_read_b128 v[88:91], v31 offset:17600
    ds_read_b128 v[92:95], v31 offset:256
    ds_read_b128 v[96:99], v31 offset:8960
    ds_read_b128 v[100:103], v31 offset:17664
    ds_read_b128 v[104:107], v31 offset:320
    ds_read_b128 v[108:111], v31 offset:9024
    s_waitcnt vmcnt(24)
    s_waitcnt lgkmcnt(7)
    v_mfma_f32_16x16x32_bf16 v[168:171], v[80:83], a[24:27], v[168:171]
    v_mfma_f32_16x16x32_bf16 v[172:175], v[80:83], a[28:31], v[172:175]
    ds_read_b128 v[80:83], v31 offset:17728
    s_waitcnt lgkmcnt(7)
    v_mfma_f32_16x16x32_bf16 v[176:179], v[84:87], a[24:27], v[176:179]
    v_mfma_f32_16x16x32_bf16 v[180:183], v[84:87], a[28:31], v[180:183]
    ds_read_b128 v[84:87], v31 offset:384
    s_waitcnt lgkmcnt(7)
    v_mfma_f32_16x16x32_bf16 v[184:187], v[88:91], a[24:27], v[184:187]
    v_mfma_f32_16x16x32_bf16 v[188:191], v[88:91], a[28:31], v[188:191]
    ds_read_b128 v[88:91], v31 offset:9088
    s_waitcnt vmcnt(22)
    s_waitcnt lgkmcnt(7)
    v_mfma_f32_16x16x32_bf16 v[168:171], v[92:95], a[32:35], v[168:171]
    v_mfma_f32_16x16x32_bf16 v[172:175], v[92:95], a[36:39], v[172:175]
    ds_read_b128 v[92:95], v31 offset:17792
    s_waitcnt lgkmcnt(7)
    v_mfma_f32_16x16x32_bf16 v[176:179], v[96:99], a[32:35], v[176:179]
    v_mfma_f32_16x16x32_bf16 v[180:183], v[96:99], a[36:39], v[180:183]
    ds_read_b128 v[96:99], v31 offset:448
    s_waitcnt lgkmcnt(7)
    v_mfma_f32_16x16x32_bf16 v[184:187], v[100:103], a[32:35], v[184:187]
    v_mfma_f32_16x16x32_bf16 v[188:191], v[100:103], a[36:39], v[188:191]
    ds_read_b128 v[100:103], v31 offset:9152
    s_waitcnt vmcnt(20)
    s_waitcnt lgkmcnt(7)
    v_mfma_f32_16x16x32_bf16 v[168:171], v[104:107], a[40:43], v[168:171]
    v_mfma_f32_16x16x32_bf16 v[172:175], v[104:107], a[44:47], v[172:175]
    ds_read_b128 v[104:107], v31 offset:17856
    s_waitcnt lgkmcnt(7)
    v_mfma_f32_16x16x32_bf16 v[176:179], v[108:111], a[40:43], v[176:179]
    v_mfma_f32_16x16x32_bf16 v[180:183], v[108:111], a[44:47], v[180:183]
    s_waitcnt lgkmcnt(6)
    v_mfma_f32_16x16x32_bf16 v[184:187], v[80:83], a[40:43], v[184:187]
    v_mfma_f32_16x16x32_bf16 v[188:191], v[80:83], a[44:47], v[188:191]
    s_waitcnt vmcnt(18)
    s_waitcnt lgkmcnt(5)
    v_mfma_f32_16x16x32_bf16 v[168:171], v[84:87], a[48:51], v[168:171]
    v_mfma_f32_16x16x32_bf16 v[172:175], v[84:87], a[52:55], v[172:175]
    s_waitcnt lgkmcnt(4)
    v_mfma_f32_16x16x32_bf16 v[176:179], v[88:91], a[48:51], v[176:179]
    v_mfma_f32_16x16x32_bf16 v[180:183], v[88:91], a[52:55], v[180:183]
    s_waitcnt lgkmcnt(3)
    v_mfma_f32_16x16x32_bf16 v[184:187], v[92:95], a[48:51], v[184:187]
    v_mfma_f32_16x16x32_bf16 v[188:191], v[92:95], a[52:55], v[188:191]
    s_waitcnt vmcnt(16)
    s_waitcnt lgkmcnt(2)
    v_mfma_f32_16x16x32_bf16 v[168:171], v[96:99], a[56:59], v[168:171]
    v_mfma_f32_16x16x32_bf16 v[172:175], v[96:99], a[60:63], v[172:175]
    s_waitcnt lgkmcnt(1)
    v_mfma_f32_16x16x32_bf16 v[176:179], v[100:103], a[56:59], v[176:179]
    v_mfma_f32_16x16x32_bf16 v[180:183], v[100:103], a[60:63], v[180:183]
    s_waitcnt lgkmcnt(0)
    v_mfma_f32_16x16x32_bf16 v[184:187], v[104:107], a[56:59], v[184:187]
    v_mfma_f32_16x16x32_bf16 v[188:191], v[104:107], a[60:63], v[188:191]
    v_lshrrev_b32 v30, 5, v14
    v_lshlrev_b32 v30, 12, v30
    v_bfe_u32 v31, v14, 4, 1
    v_lshl_add_u32 v30, v31, 9, v30
    v_and_b32 v31, 15, v14
    v_lshl_add_u32 v30, v31, 4, v30
    s_lshr_b32 s3, s47, 1
    s_lshl_b32 s3, s3, 10
    s_and_b32 s78, s47, 1
    s_lshl_b32 s78, s78, 8
    s_add_u32 s3, s3, s78
    s_add_u32 s3, s3, 128192
    v_add_u32 v30, s3, v30
    v_pk_mul_f32 v[168:169], v[168:169], s[76:77]
    v_pk_mul_f32 v[170:171], v[170:171], s[76:77]
    v_pk_mul_f32 v[172:173], v[172:173], s[76:77]
    v_pk_mul_f32 v[174:175], v[174:175], s[76:77]
    v_cvt_pk_bf16_f32 v168, v168, v172
    v_cvt_pk_bf16_f32 v169, v169, v173
    v_cvt_pk_bf16_f32 v170, v170, v174
    v_cvt_pk_bf16_f32 v171, v171, v175
    ds_write_b128 v30, v[168:171] offset:0
    v_pk_mul_f32 v[176:177], v[176:177], s[76:77]
    v_pk_mul_f32 v[178:179], v[178:179], s[76:77]
    v_pk_mul_f32 v[180:181], v[180:181], s[76:77]
    v_pk_mul_f32 v[182:183], v[182:183], s[76:77]
    v_cvt_pk_bf16_f32 v176, v176, v180
    v_cvt_pk_bf16_f32 v177, v177, v181
    v_cvt_pk_bf16_f32 v178, v178, v182
    v_cvt_pk_bf16_f32 v179, v179, v183
    ds_write_b128 v30, v[176:179] offset:8192
    v_pk_mul_f32 v[184:185], v[184:185], s[76:77]
    v_pk_mul_f32 v[186:187], v[186:187], s[76:77]
    v_pk_mul_f32 v[188:189], v[188:189], s[76:77]
    v_pk_mul_f32 v[190:191], v[190:191], s[76:77]
    v_cvt_pk_bf16_f32 v184, v184, v188
    v_cvt_pk_bf16_f32 v185, v185, v189
    v_cvt_pk_bf16_f32 v186, v186, v190
    v_cvt_pk_bf16_f32 v187, v187, v191
    s_mov_b32 exec_hi, 0
    ds_write_b128 v30, v[184:187] offset:16384
    s_mov_b64 exec, -1
egnn_edge_kernel_noA:
    v_mfma_f32_32x32x8bf16_1k v[80:95], v[10:11], v[10:11], 0
    v_mfma_f32_32x32x8bf16_1k v[96:111], v[10:11], v[10:11], 0
    v_pk_mov_b32 v[160:161], v[10:11], v[10:11]
    v_pk_mov_b32 v[162:163], v[10:11], v[10:11]
    v_pk_mov_b32 v[64:65], v[10:11], v[10:11]
    v_pk_mov_b32 v[66:67], v[10:11], v[10:11]
    v_pk_mov_b32 v[68:69], v[10:11], v[10:11]
    v_pk_mov_b32 v[70:71], v[10:11], v[10:11]
    s_waitcnt lgkmcnt(0)
    s_barrier
    ds_read_u16 v5, v3
    ds_read_b64 v[164:165], v2
    ds_read_b128 v[152:155], v6
    ds_read_b128 v[72:75], v4 offset:128
    ds_read_b128 v[76:79], v4 offset:144
    ds_write_b32 v147, v10 offset:0
    ds_write_b32 v147, v10 offset:128
    ds_write_b32 v147, v10 offset:256
    ds_write_b32 v147, v10 offset:384
    ds_write_b32 v147, v10 offset:512
    s_waitcnt lgkmcnt(9)
    ds_read_b128 v[156:159], v5
    ds_read_u16 v5, v3 offset:128
    s_waitcnt lgkmcnt(10)
    v_mfma_f32_32x32x8bf16_1k v[16:31], v[164:165], v[166:167], 0
    s_mul_i32 s3, s64, 4352
    v_add_u32 v7, s3, v146
    s_lshl_b32 s3, s64, 7
    v_add_u32 v8, s3, v147
    v_add_u32 v14, 106432, v12
    s_nop 3
    s_waitcnt lgkmcnt(0)
    v_mfma_f32_32x32x16_bf16 v[16:31], v[156:159], v[152:155], v[16:31]
    s_nop 8
    s_waitcnt vmcnt(8)
    v_mfma_f32_4x4x4bf16_1k v[16:19], v[144:145], v[112:113], v[16:19]
    v_mfma_f32_4x4x4bf16_1k v[20:23], v[144:145], v[114:115], v[20:23]
    v_mfma_f32_4x4x4bf16_1k v[24:27], v[144:145], v[116:117], v[24:27]
    v_mfma_f32_4x4x4bf16_1k v[28:31], v[144:145], v[118:119], v[28:31]
    buffer_load_dword v112, v72, s[24:27], 0 offen
    buffer_load_dword v113, v73, s[24:27], 0 offen
    buffer_load_dword v114, v74, s[24:27], 0 offen
    buffer_load_dword v115, v75, s[24:27], 0 offen
    buffer_load_dword v116, v76, s[24:27], 0 offen
    buffer_load_dword v117, v77, s[24:27], 0 offen
    buffer_load_dword v118, v78, s[24:27], 0 offen
    buffer_load_dword v119, v79, s[24:27], 0 offen
    s_min_u32 s99, s54, s63
    s_cmp_eq_u32 s54, s61
    s_cbranch_scc0 egnn_edge_kernel_noy0
    s_add_u32 s64, s64, 1
    s_min_u32 m0, s64, 4
    s_cmp_lt_u32 s64, 5
    s_movrels_b32 s54, s56
    s_cselect_b32 s3, 4096, 0
    v_add_u32 v6, s3, v6
    s_cselect_b32 s3, -1, 1000
    s_add_u32 s54, s54, s3
    ds_read_b128 v[152:155], v6
    s_min_u32 s99, s54, s63
egnn_edge_kernel_noy0:
    s_cmp_eq_u32 s65, 0
    s_cbranch_scc0 egnn_edge_kernel_loop
    s_setprio 3
    ds_read_b64 v[164:165], v2 offset:256
    ds_read_b128 v[156:159], v5
    ds_read_u16 v5, v3 offset:256
    ds_read_b128 v[72:75], v4 offset:192
    ds_read_b128 v[76:79], v4 offset:208
    v_exp_f32 v48, v16
    v_mfma_f32_32x32x16_bf16 v[80:95], v[64:67], v[160:163], v[80:95]
    v_exp_f32 v49, v17
    v_exp_f32 v50, v18
    v_exp_f32 v51, v19
    v_exp_f32 v52, v20
    v_mfma_f32_32x32x16_bf16 v[96:111], v[68:71], v[160:163], v[96:111]
    ds_read_b128 v[160:163], v1 offset:0
    v_exp_f32 v53, v21
    v_exp_f32 v54, v22
    v_exp_f32 v55, v23
    s_waitcnt lgkmcnt(5)
    v_mfma_f32_32x32x8bf16_1k v[32:47], v[164:165], v[166:167], 0
    v_exp_f32 v56, v24
    v_exp_f32 v57, v25
    v_exp_f32 v58, v26
    v_exp_f32 v59, v27
    s_mov_b32 s3, 131072
    buffer_load_dwordx4 a[0:3], v13, s[36:39], s3 offen offset:0
    buffer_load_dwordx4 a[4:7], v13, s[36:39], s3 offen offset:1024
    v_exp_f32 v60, v28
    v_exp_f32 v61, v29
    v_exp_f32 v62, v30
    v_exp_f32 v63, v31
    v_pk_add_f32 v[48:49], v[48:49], 1.0 op_sel_hi:[1,0]
    v_pk_add_f32 v[50:51], v[50:51], 1.0 op_sel_hi:[1,0]
    v_pk_add_f32 v[52:53], v[52:53], 1.0 op_sel_hi:[1,0]
    v_pk_add_f32 v[54:55], v[54:55], 1.0 op_sel_hi:[1,0]
    v_pk_add_f32 v[56:57], v[56:57], 1.0 op_sel_hi:[1,0]
    v_pk_add_f32 v[58:59], v[58:59], 1.0 op_sel_hi:[1,0]
    v_pk_add_f32 v[60:61], v[60:61], 1.0 op_sel_hi:[1,0]
    v_pk_add_f32 v[62:63], v[62:63], 1.0 op_sel_hi:[1,0]
    s_waitcnt lgkmcnt(1)
    v_mfma_f32_32x32x16_bf16 v[32:47], v[156:159], v[152:155], v[32:47]
    v_rcp_f32 v48, v48
    v_rcp_f32 v49, v49
    v_rcp_f32 v50, v50
    v_rcp_f32 v51, v51
    v_rcp_f32 v52, v52
    v_rcp_f32 v53, v53
    v_rcp_f32 v54, v54
    v_rcp_f32 v55, v55
    v_rcp_f32 v56, v56
    v_rcp_f32 v57, v57
    s_waitcnt vmcnt(10)
    v_mfma_f32_4x4x4bf16_1k v[32:35], v[144:145], v[120:121], v[32:35]
    v_rcp_f32 v58, v58
    buffer_load_dword v120, v72, s[24:27], 0 offen
    buffer_load_dword v121, v73, s[24:27], 0 offen
    v_mfma_f32_4x4x4bf16_1k v[36:39], v[144:145], v[122:123], v[36:39]
    v_rcp_f32 v59, v59
    buffer_load_dword v122, v74, s[24:27], 0 offen
    buffer_load_dword v123, v75, s[24:27], 0 offen
    v_mfma_f32_4x4x4bf16_1k v[40:43], v[144:145], v[124:125], v[40:43]
    v_rcp_f32 v60, v60
    buffer_load_dword v124, v76, s[24:27], 0 offen
    buffer_load_dword v125, v77, s[24:27], 0 offen
    v_mfma_f32_4x4x4bf16_1k v[44:47], v[144:145], v[126:127], v[44:47]
    v_rcp_f32 v61, v61
    buffer_load_dword v126, v78, s[24:27], 0 offen
    buffer_load_dword v127, v79, s[24:27], 0 offen
    v_rcp_f32 v62, v62
    v_rcp_f32 v63, v63
    v_pk_mul_f32 v[48:49], v[48:49], v[16:17]
    v_pk_mul_f32 v[50:51], v[50:51], v[18:19]
    v_pk_mul_f32 v[52:53], v[52:53], v[20:21]
    v_pk_mul_f32 v[54:55], v[54:55], v[22:23]
    v_pk_mul_f32 v[56:57], v[56:57], v[24:25]
    v_pk_mul_f32 v[58:59], v[58:59], v[26:27]
    v_pk_mul_f32 v[60:61], v[60:61], v[28:29]
    v_pk_mul_f32 v[62:63], v[62:63], v[30:31]
    v_cvt_pk_bf16_f32 v64, v48, v50
    v_cvt_pk_bf16_f32 v65, v52, v54
    v_cvt_pk_bf16_f32 v66, v56, v58
    v_cvt_pk_bf16_f32 v67, v60, v62
    v_cvt_pk_bf16_f32 v68, v49, v51
    v_cvt_pk_bf16_f32 v69, v53, v55
    v_cvt_pk_bf16_f32 v70, v57, v59
    v_cvt_pk_bf16_f32 v71, v61, v63
    s_add_u32 s61, s61, 1
    s_cmp_eq_u32 s61, s99
    s_waitcnt lgkmcnt(0)
    s_cbranch_scc1 egnn_edge_kernel_eva0
egnn_edge_kernel_nexta0:
    s_setprio 2
    ds_read_b64 v[164:165], v2 offset:512
    ds_read_b128 v[156:159], v5
    ds_read_u16 v5, v3 offset:384
    ds_read_b128 v[72:75], v4 offset:256
    ds_read_b128 v[76:79], v4 offset:272
    v_exp_f32 v48, v32
    v_mfma_f32_32x32x16_bf16 v[80:95], v[64:67], v[160:163], v[80:95]
    v_exp_f32 v49, v33
    v_exp_f32 v50, v34
    v_exp_f32 v51, v35
    v_exp_f32 v52, v36
    v_mfma_f32_32x32x16_bf16 v[96:111], v[68:71], v[160:163], v[96:111]
    ds_read_b128 v[160:163], v1 offset:1024
    v_exp_f32 v53, v37
    v_exp_f32 v54, v38
    v_exp_f32 v55, v39
    s_waitcnt lgkmcnt(5)
    v_mfma_f32_32x32x8bf16_1k v[16:31], v[164:165], v[166:167], 0
    v_exp_f32 v56, v40
    v_exp_f32 v57, v41
    v_exp_f32 v58, v42
    v_exp_f32 v59, v43
    s_mov_b32 s3, 131072
    buffer_load_dwordx4 a[8:11], v13, s[36:39], s3 offen offset:2048
    buffer_load_dwordx4 a[12:15], v13, s[36:39], s3 offen offset:3072
    v_exp_f32 v60, v44
    v_exp_f32 v61, v45
    v_exp_f32 v62, v46
    v_exp_f32 v63, v47
    v_pk_add_f32 v[48:49], v[48:49], 1.0 op_sel_hi:[1,0]
    v_pk_add_f32 v[50:51], v[50:51], 1.0 op_sel_hi:[1,0]
    v_pk_add_f32 v[52:53], v[52:53], 1.0 op_sel_hi:[1,0]
    v_pk_add_f32 v[54:55], v[54:55], 1.0 op_sel_hi:[1,0]
    v_pk_add_f32 v[56:57], v[56:57], 1.0 op_sel_hi:[1,0]
    v_pk_add_f32 v[58:59], v[58:59], 1.0 op_sel_hi:[1,0]
    v_pk_add_f32 v[60:61], v[60:61], 1.0 op_sel_hi:[1,0]
    v_pk_add_f32 v[62:63], v[62:63], 1.0 op_sel_hi:[1,0]
    s_waitcnt lgkmcnt(1)
    v_mfma_f32_32x32x16_bf16 v[16:31], v[156:159], v[152:155], v[16:31]
    v_rcp_f32 v48, v48
    v_rcp_f32 v49, v49
    v_rcp_f32 v50, v50
    v_rcp_f32 v51, v51
    v_rcp_f32 v52, v52
    v_rcp_f32 v53, v53
    v_rcp_f32 v54, v54
    v_rcp_f32 v55, v55
    v_rcp_f32 v56, v56
    v_rcp_f32 v57, v57
    s_waitcnt vmcnt(12)
    v_mfma_f32_4x4x4bf16_1k v[16:19], v[144:145], v[112:113], v[16:19]
    v_rcp_f32 v58, v58
    buffer_load_dword v112, v72, s[24:27], 0 offen
    buffer_load_dword v113, v73, s[24:27], 0 offen
    v_mfma_f32_4x4x4bf16_1k v[20:23], v[144:145], v[114:115], v[20:23]
    v_rcp_f32 v59, v59
    buffer_load_dword v114, v74, s[24:27], 0 offen
    buffer_load_dword v115, v75, s[24:27], 0 offen
    v_mfma_f32_4x4x4bf16_1k v[24:27], v[144:145], v[116:117], v[24:27]
    v_rcp_f32 v60, v60
    buffer_load_dword v116, v76, s[24:27], 0 offen
    buffer_load_dword v117, v77, s[24:27], 0 offen
    v_mfma_f32_4x4x4bf16_1k v[28:31], v[144:145], v[118:119], v[28:31]
    v_rcp_f32 v61, v61
    buffer_load_dword v118, v78, s[24:27], 0 offen
    buffer_load_dword v119, v79, s[24:27], 0 offen
    v_rcp_f32 v62, v62
    v_rcp_f32 v63, v63
    v_pk_mul_f32 v[48:49], v[48:49], v[32:33]
    v_pk_mul_f32 v[50:51], v[50:51], v[34:35]
    v_pk_mul_f32 v[52:53], v[52:53], v[36:37]
    v_pk_mul_f32 v[54:55], v[54:55], v[38:39]
    v_pk_mul_f32 v[56:57], v[56:57], v[40:41]
    v_pk_mul_f32 v[58:59], v[58:59], v[42:43]
    v_pk_mul_f32 v[60:61], v[60:61], v[44:45]
    v_pk_mul_f32 v[62:63], v[62:63], v[46:47]
    v_cvt_pk_bf16_f32 v64, v48, v50
    v_cvt_pk_bf16_f32 v65, v52, v54
    v_cvt_pk_bf16_f32 v66, v56, v58
    v_cvt_pk_bf16_f32 v67, v60, v62
    v_cvt_pk_bf16_f32 v68, v49, v51
    v_cvt_pk_bf16_f32 v69, v53, v55
    v_cvt_pk_bf16_f32 v70, v57, v59
    v_cvt_pk_bf16_f32 v71, v61, v63
    s_add_u32 s61, s61, 1
    s_cmp_eq_u32 s61, s99
    s_waitcnt lgkmcnt(0)
    s_cbranch_scc1 egnn_edge_kernel_eva1
egnn_edge_kernel_nexta1:
    s_setprio 1
    ds_read_b64 v[164:165], v2 offset:768
    ds_read_b128 v[156:159], v5
    ds_read_u16 v5, v3 offset:512
    ds_read_b128 v[72:75], v4 offset:320
    ds_read_b128 v[76:79], v4 offset:336
    v_exp_f32 v48, v16
    v_mfma_f32_32x32x16_bf16 v[80:95], v[64:67], v[160:163], v[80:95]
    v_exp_f32 v49, v17
    v_exp_f32 v50, v18
    v_exp_f32 v51, v19
    v_exp_f32 v52, v20
    v_mfma_f32_32x32x16_bf16 v[96:111], v[68:71], v[160:163], v[96:111]
    ds_read_b128 v[160:163], v1 offset:2048
    v_exp_f32 v53, v21
    v_exp_f32 v54, v22
    v_exp_f32 v55, v23
    s_waitcnt lgkmcnt(5)
    v_mfma_f32_32x32x8bf16_1k v[32:47], v[164:165], v[166:167], 0
    v_exp_f32 v56, v24
    v_exp_f32 v57, v25
    v_exp_f32 v58, v26
    v_exp_f32 v59, v27
    s_mov_b32 s3, 135168
    buffer_load_dwordx4 a[16:19], v13, s[36:39], s3 offen offset:0
    buffer_load_dwordx4 a[20:23], v13, s[36:39], s3 offen offset:1024
    v_exp_f32 v60, v28
    v_exp_f32 v61, v29
    v_exp_f32 v62, v30
    v_exp_f32 v63, v31
    v_pk_add_f32 v[48:49], v[48:49], 1.0 op_sel_hi:[1,0]
    v_pk_add_f32 v[50:51], v[50:51], 1.0 op_sel_hi:[1,0]
    v_pk_add_f32 v[52:53], v[52:53], 1.0 op_sel_hi:[1,0]
    v_pk_add_f32 v[54:55], v[54:55], 1.0 op_sel_hi:[1,0]
    v_pk_add_f32 v[56:57], v[56:57], 1.0 op_sel_hi:[1,0]
    v_pk_add_f32 v[58:59], v[58:59], 1.0 op_sel_hi:[1,0]
    v_pk_add_f32 v[60:61], v[60:61], 1.0 op_sel_hi:[1,0]
    v_pk_add_f32 v[62:63], v[62:63], 1.0 op_sel_hi:[1,0]
    s_waitcnt lgkmcnt(1)
    v_mfma_f32_32x32x16_bf16 v[32:47], v[156:159], v[152:155], v[32:47]
    v_rcp_f32 v48, v48
    v_rcp_f32 v49, v49
    v_rcp_f32 v50, v50
    v_rcp_f32 v51, v51
    v_rcp_f32 v52, v52
    v_rcp_f32 v53, v53
    v_rcp_f32 v54, v54
    v_rcp_f32 v55, v55
    v_rcp_f32 v56, v56
    v_rcp_f32 v57, v57
    s_waitcnt vmcnt(12)
    v_mfma_f32_4x4x4bf16_1k v[32:35], v[144:145], v[120:121], v[32:35]
    v_rcp_f32 v58, v58
    buffer_load_dword v120, v72, s[24:27], 0 offen
    buffer_load_dword v121, v73, s[24:27], 0 offen
    v_mfma_f32_4x4x4bf16_1k v[36:39], v[144:145], v[122:123], v[36:39]
    v_rcp_f32 v59, v59
    buffer_load_dword v122, v74, s[24:27], 0 offen
    buffer_load_dword v123, v75, s[24:27], 0 offen
    v_mfma_f32_4x4x4bf16_1k v[40:43], v[144:145], v[124:125], v[40:43]
    v_rcp_f32 v60, v60
    buffer_load_dword v124, v76, s[24:27], 0 offen
    buffer_load_dword v125, v77, s[24:27], 0 offen
    v_mfma_f32_4x4x4bf16_1k v[44:47], v[144:145], v[126:127], v[44:47]
    v_rcp_f32 v61, v61
    buffer_load_dword v126, v78, s[24:27], 0 offen
    buffer_load_dword v127, v79, s[24:27], 0 offen
    v_rcp_f32 v62, v62
    v_rcp_f32 v63, v63
    v_pk_mul_f32 v[48:49], v[48:49], v[16:17]
    v_pk_mul_f32 v[50:51], v[50:51], v[18:19]
    v_pk_mul_f32 v[52:53], v[52:53], v[20:21]
    v_pk_mul_f32 v[54:55], v[54:55], v[22:23]
    v_pk_mul_f32 v[56:57], v[56:57], v[24:25]
    v_pk_mul_f32 v[58:59], v[58:59], v[26:27]
    v_pk_mul_f32 v[60:61], v[60:61], v[28:29]
    v_pk_mul_f32 v[62:63], v[62:63], v[30:31]
    v_cvt_pk_bf16_f32 v64, v48, v50
    v_cvt_pk_bf16_f32 v65, v52, v54
    v_cvt_pk_bf16_f32 v66, v56, v58
    v_cvt_pk_bf16_f32 v67, v60, v62
    v_cvt_pk_bf16_f32 v68, v49, v51
    v_cvt_pk_bf16_f32 v69, v53, v55
    v_cvt_pk_bf16_f32 v70, v57, v59
    v_cvt_pk_bf16_f32 v71, v61, v63
    s_add_u32 s61, s61, 1
    s_cmp_eq_u32 s61, s99
    s_waitcnt lgkmcnt(0)
    s_cbranch_scc1 egnn_edge_kernel_eva2
egnn_edge_kernel_nexta2:
    s_setprio 0
    ds_read_b64 v[164:165], v2 offset:1024
    ds_read_b128 v[156:159], v5
    ds_read_u16 v5, v3 offset:640
    ds_read_b128 v[72:75], v4 offset:384
    ds_read_b128 v[76:79], v4 offset:400
    v_exp_f32 v48, v32
    v_mfma_f32_32x32x16_bf16 v[80:95], v[64:67], v[160:163], v[80:95]
    v_exp_f32 v49, v33
    v_exp_f32 v50, v34
    v_exp_f32 v51, v35
    v_exp_f32 v52, v36
    v_mfma_f32_32x32x16_bf16 v[96:111], v[68:71], v[160:163], v[96:111]
    ds_read_b128 v[160:163], v1 offset:3072
    v_exp_f32 v53, v37
    v_exp_f32 v54, v38
    v_exp_f32 v55, v39
    s_waitcnt lgkmcnt(5)
    v_mfma_f32_32x32x8bf16_1k v[16:31], v[164:165], v[166:167], 0
    v_exp_f32 v56, v40
    v_exp_f32 v57, v41
    v_exp_f32 v58, v42
    v_exp_f32 v59, v43
    s_mov_b32 s3, 135168
    buffer_load_dwordx4 a[24:27], v13, s[36:39], s3 offen offset:2048
    buffer_load_dwordx4 a[28:31], v13, s[36:39], s3 offen offset:3072
    v_exp_f32 v60, v44
    v_exp_f32 v61, v45
    v_exp_f32 v62, v46
    v_exp_f32 v63, v47
    v_pk_add_f32 v[48:49], v[48:49], 1.0 op_sel_hi:[1,0]
    v_pk_add_f32 v[50:51], v[50:51], 1.0 op_sel_hi:[1,0]
    v_pk_add_f32 v[52:53], v[52:53], 1.0 op_sel_hi:[1,0]
    v_pk_add_f32 v[54:55], v[54:55], 1.0 op_sel_hi:[1,0]
    v_pk_add_f32 v[56:57], v[56:57], 1.0 op_sel_hi:[1,0]
    v_pk_add_f32 v[58:59], v[58:59], 1.0 op_sel_hi:[1,0]
    v_pk_add_f32 v[60:61], v[60:61], 1.0 op_sel_hi:[1,0]
    v_pk_add_f32 v[62:63], v[62:63], 1.0 op_sel_hi:[1,0]
    s_waitcnt lgkmcnt(1)
    v_mfma_f32_32x32x16_bf16 v[16:31], v[156:159], v[152:155], v[16:31]
    v_rcp_f32 v48, v48
    v_rcp_f32 v49, v49
    v_rcp_f32 v50, v50
    v_rcp_f32 v51, v51
    v_rcp_f32 v52, v52
    v_rcp_f32 v53, v53
    v_rcp_f32 v54, v54
    v_rcp_f32 v55, v55
    v_rcp_f32 v56, v56
    v_rcp_f32 v57, v57
    s_waitcnt vmcnt(12)
    v_mfma_f32_4x4x4bf16_1k v[16:19], v[144:145], v[112:113], v[16:19]
    v_rcp_f32 v58, v58
    buffer_load_dword v112, v72, s[24:27], 0 offen
    buffer_load_dword v113, v73, s[24:27], 0 offen
    v_mfma_f32_4x4x4bf16_1k v[20:23], v[144:145], v[114:115], v[20:23]
    v_rcp_f32 v59, v59
    buffer_load_dword v114, v74, s[24:27], 0 offen
    buffer_load_dword v115, v75, s[24:27], 0 offen
    v_mfma_f32_4x4x4bf16_1k v[24:27], v[144:145], v[116:117], v[24:27]
    v_rcp_f32 v60, v60
    buffer_load_dword v116, v76, s[24:27], 0 offen
    buffer_load_dword v117, v77, s[24:27], 0 offen
    v_mfma_f32_4x4x4bf16_1k v[28:31], v[144:145], v[118:119], v[28:31]
    v_rcp_f32 v61, v61
    buffer_load_dword v118, v78, s[24:27], 0 offen
    buffer_load_dword v119, v79, s[24:27], 0 offen
    v_rcp_f32 v62, v62
    v_rcp_f32 v63, v63
    v_pk_mul_f32 v[48:49], v[48:49], v[32:33]
    v_pk_mul_f32 v[50:51], v[50:51], v[34:35]
    v_pk_mul_f32 v[52:53], v[52:53], v[36:37]
    v_pk_mul_f32 v[54:55], v[54:55], v[38:39]
    v_pk_mul_f32 v[56:57], v[56:57], v[40:41]
    v_pk_mul_f32 v[58:59], v[58:59], v[42:43]
    v_pk_mul_f32 v[60:61], v[60:61], v[44:45]
    v_pk_mul_f32 v[62:63], v[62:63], v[46:47]
    v_cvt_pk_bf16_f32 v64, v48, v50
    v_cvt_pk_bf16_f32 v65, v52, v54
    v_cvt_pk_bf16_f32 v66, v56, v58
    v_cvt_pk_bf16_f32 v67, v60, v62
    v_cvt_pk_bf16_f32 v68, v49, v51
    v_cvt_pk_bf16_f32 v69, v53, v55
    v_cvt_pk_bf16_f32 v70, v57, v59
    v_cvt_pk_bf16_f32 v71, v61, v63
    s_add_u32 s61, s61, 1
    s_cmp_eq_u32 s61, s99
    s_waitcnt lgkmcnt(0)
    s_cbranch_scc1 egnn_edge_kernel_eva3
egnn_edge_kernel_nexta3:
    s_setprio 3
    ds_read_b64 v[164:165], v2 offset:1280
    ds_read_b128 v[156:159], v5
    ds_read_u16 v5, v3 offset:768
    ds_read_b128 v[72:75], v4 offset:448
    ds_read_b128 v[76:79], v4 offset:464
    v_exp_f32 v48, v16
    v_mfma_f32_32x32x16_bf16 v[80:95], v[64:67], v[160:163], v[80:95]
    v_exp_f32 v49, v17
    v_exp_f32 v50, v18
    v_exp_f32 v51, v19
    v_exp_f32 v52, v20
    v_mfma_f32_32x32x16_bf16 v[96:111], v[68:71], v[160:163], v[96:111]
    ds_read_b128 v[160:163], v1 offset:4096
    v_exp_f32 v53, v21
    v_exp_f32 v54, v22
    v_exp_f32 v55, v23
    s_waitcnt lgkmcnt(5)
    v_mfma_f32_32x32x8bf16_1k v[32:47], v[164:165], v[166:167], 0
    v_exp_f32 v56, v24
    v_exp_f32 v57, v25
    v_exp_f32 v58, v26
    v_exp_f32 v59, v27
    s_mov_b32 s3, 139264
    buffer_load_dwordx4 a[32:35], v13, s[36:39], s3 offen offset:0
    buffer_load_dwordx4 a[36:39], v13, s[36:39], s3 offen offset:1024
    v_exp_f32 v60, v28
    v_exp_f32 v61, v29
    v_exp_f32 v62, v30
    v_exp_f32 v63, v31
    v_pk_add_f32 v[48:49], v[48:49], 1.0 op_sel_hi:[1,0]
    v_pk_add_f32 v[50:51], v[50:51], 1.0 op_sel_hi:[1,0]
    v_pk_add_f32 v[52:53], v[52:53], 1.0 op_sel_hi:[1,0]
    v_pk_add_f32 v[54:55], v[54:55], 1.0 op_sel_hi:[1,0]
    v_pk_add_f32 v[56:57], v[56:57], 1.0 op_sel_hi:[1,0]
    v_pk_add_f32 v[58:59], v[58:59], 1.0 op_sel_hi:[1,0]
    v_pk_add_f32 v[60:61], v[60:61], 1.0 op_sel_hi:[1,0]
    v_pk_add_f32 v[62:63], v[62:63], 1.0 op_sel_hi:[1,0]
    s_waitcnt lgkmcnt(1)
    v_mfma_f32_32x32x16_bf16 v[32:47], v[156:159], v[152:155], v[32:47]
    v_rcp_f32 v48, v48
    v_rcp_f32 v49, v49
    v_rcp_f32 v50, v50
    v_rcp_f32 v51, v51
    v_rcp_f32 v52, v52
    v_rcp_f32 v53, v53
    v_rcp_f32 v54, v54
    v_rcp_f32 v55, v55
    v_rcp_f32 v56, v56
    v_rcp_f32 v57, v57
    s_waitcnt vmcnt(12)
    v_mfma_f32_4x4x4bf16_1k v[32:35], v[144:145], v[120:121], v[32:35]
    v_rcp_f32 v58, v58
    buffer_load_dword v120, v72, s[24:27], 0 offen
    buffer_load_dword v121, v73, s[24:27], 0 offen
    v_mfma_f32_4x4x4bf16_1k v[36:39], v[144:145], v[122:123], v[36:39]
    v_rcp_f32 v59, v59
    buffer_load_dword v122, v74, s[24:27], 0 offen
    buffer_load_dword v123, v75, s[24:27], 0 offen
    v_mfma_f32_4x4x4bf16_1k v[40:43], v[144:145], v[124:125], v[40:43]
    v_rcp_f32 v60, v60
    buffer_load_dword v124, v76, s[24:27], 0 offen
    buffer_load_dword v125, v77, s[24:27], 0 offen
    v_mfma_f32_4x4x4bf16_1k v[44:47], v[144:145], v[126:127], v[44:47]
    v_rcp_f32 v61, v61
    buffer_load_dword v126, v78, s[24:27], 0 offen
    buffer_load_dword v127, v79, s[24:27], 0 offen
    v_rcp_f32 v62, v62
    v_rcp_f32 v63, v63
    v_pk_mul_f32 v[48:49], v[48:49], v[16:17]
    v_pk_mul_f32 v[50:51], v[50:51], v[18:19]
    v_pk_mul_f32 v[52:53], v[52:53], v[20:21]
    v_pk_mul_f32 v[54:55], v[54:55], v[22:23]
    v_pk_mul_f32 v[56:57], v[56:57], v[24:25]
    v_pk_mul_f32 v[58:59], v[58:59], v[26:27]
    v_pk_mul_f32 v[60:61], v[60:61], v[28:29]
    v_pk_mul_f32 v[62:63], v[62:63], v[30:31]
    v_cvt_pk_bf16_f32 v64, v48, v50
    v_cvt_pk_bf16_f32 v65, v52, v54
    v_cvt_pk_bf16_f32 v66, v56, v58
    v_cvt_pk_bf16_f32 v67, v60, v62
    v_cvt_pk_bf16_f32 v68, v49, v51
    v_cvt_pk_bf16_f32 v69, v53, v55
    v_cvt_pk_bf16_f32 v70, v57, v59
    v_cvt_pk_bf16_f32 v71, v61, v63
    s_add_u32 s61, s61, 1
    s_cmp_eq_u32 s61, s99
    s_waitcnt lgkmcnt(0)
    s_cbranch_scc1 egnn_edge_kernel_eva4
egnn_edge_kernel_nexta4:
    s_setprio 2
    ds_read_b64 v[164:165], v2 offset:1536
    ds_read_b128 v[156:159], v5
    ds_read_u16 v5, v3 offset:896
    ds_read_b128 v[72:75], v4 offset:512
    ds_read_b128 v[76:79], v4 offset:528
    v_exp_f32 v48, v32
    v_mfma_f32_32x32x16_bf16 v[80:95], v[64:67], v[160:163], v[80:95]
    v_exp_f32 v49, v33
    v_exp_f32 v50, v34
    v_exp_f32 v51, v35
    v_exp_f32 v52, v36
    v_mfma_f32_32x32x16_bf16 v[96:111], v[68:71], v[160:163], v[96:111]
    ds_read_b128 v[160:163], v1 offset:5120
    v_exp_f32 v53, v37
    v_exp_f32 v54, v38
    v_exp_f32 v55, v39
    s_waitcnt lgkmcnt(5)
    v_mfma_f32_32x32x8bf16_1k v[16:31], v[164:165], v[166:167], 0
    v_exp_f32 v56, v40
    v_exp_f32 v57, v41
    v_exp_f32 v58, v42
    v_exp_f32 v59, v43
    s_mov_b32 s3, 139264
    buffer_load_dwordx4 a[40:43], v13, s[36:39], s3 offen offset:2048
    buffer_load_dwordx4 a[44:47], v13, s[36:39], s3 offen offset:3072
    v_exp_f32 v60, v44
    v_exp_f32 v61, v45
    v_exp_f32 v62, v46
    v_exp_f32 v63, v47
    v_pk_add_f32 v[48:49], v[48:49], 1.0 op_sel_hi:[1,0]
    v_pk_add_f32 v[50:51], v[50:51], 1.0 op_sel_hi:[1,0]
    v_pk_add_f32 v[52:53], v[52:53], 1.0 op_sel_hi:[1,0]
    v_pk_add_f32 v[54:55], v[54:55], 1.0 op_sel_hi:[1,0]
    v_pk_add_f32 v[56:57], v[56:57], 1.0 op_sel_hi:[1,0]
    v_pk_add_f32 v[58:59], v[58:59], 1.0 op_sel_hi:[1,0]
    v_pk_add_f32 v[60:61], v[60:61], 1.0 op_sel_hi:[1,0]
    v_pk_add_f32 v[62:63], v[62:63], 1.0 op_sel_hi:[1,0]
    s_waitcnt lgkmcnt(1)
    v_mfma_f32_32x32x16_bf16 v[16:31], v[156:159], v[152:155], v[16:31]
    v_rcp_f32 v48, v48
    v_rcp_f32 v49, v49
    v_rcp_f32 v50, v50
    v_rcp_f32 v51, v51
    v_rcp_f32 v52, v52
    v_rcp_f32 v53, v53
    v_rcp_f32 v54, v54
    v_rcp_f32 v55, v55
    v_rcp_f32 v56, v56
    v_rcp_f32 v57, v57
    s_waitcnt vmcnt(12)
    v_mfma_f32_4x4x4bf16_1k v[16:19], v[144:145], v[112:113], v[16:19]
    v_rcp_f32 v58, v58
    buffer_load_dword v112, v72, s[24:27], 0 offen
    buffer_load_dword v113, v73, s[24:27], 0 offen
    v_mfma_f32_4x4x4bf16_1k v[20:23], v[144:145], v[114:115], v[20:23]
    v_rcp_f32 v59, v59
    buffer_load_dword v114, v74, s[24:27], 0 offen
    buffer_load_dword v115, v75, s[24:27], 0 offen
    v_mfma_f32_4x4x4bf16_1k v[24:27], v[144:145], v[116:117], v[24:27]
    v_rcp_f32 v60, v60
    buffer_load_dword v116, v76, s[24:27], 0 offen
    buffer_load_dword v117, v77, s[24:27], 0 offen
    v_mfma_f32_4x4x4bf16_1k v[28:31], v[144:145], v[118:119], v[28:31]
    v_rcp_f32 v61, v61
    buffer_load_dword v118, v78, s[24:27], 0 offen
    buffer_load_dword v119, v79, s[24:27], 0 offen
    v_rcp_f32 v62, v62
    v_rcp_f32 v63, v63
    v_pk_mul_f32 v[48:49], v[48:49], v[32:33]
    v_pk_mul_f32 v[50:51], v[50:51], v[34:35]
    v_pk_mul_f32 v[52:53], v[52:53], v[36:37]
    v_pk_mul_f32 v[54:55], v[54:55], v[38:39]
    v_pk_mul_f32 v[56:57], v[56:57], v[40:41]
    v_pk_mul_f32 v[58:59], v[58:59], v[42:43]
    v_pk_mul_f32 v[60:61], v[60:61], v[44:45]
    v_pk_mul_f32 v[62:63], v[62:63], v[46:47]
    v_cvt_pk_bf16_f32 v64, v48, v50
    v_cvt_pk_bf16_f32 v65, v52, v54
    v_cvt_pk_bf16_f32 v66, v56, v58
    v_cvt_pk_bf16_f32 v67, v60, v62
    v_cvt_pk_bf16_f32 v68, v49, v51
    v_cvt_pk_bf16_f32 v69, v53, v55
    v_cvt_pk_bf16_f32 v70, v57, v59
    v_cvt_pk_bf16_f32 v71, v61, v63
    s_add_u32 s61, s61, 1
    s_cmp_eq_u32 s61, s99
    s_waitcnt lgkmcnt(0)
    s_cbranch_scc1 egnn_edge_kernel_eva5
egnn_edge_kernel_nexta5:
    s_setprio 1
    ds_read_b64 v[164:165], v2 offset:1792
    ds_read_b128 v[156:159], v5
    ds_read_u16 v5, v3 offset:1024
    ds_read_b128 v[72:75], v4 offset:576
    ds_read_b128 v[76:79], v4 offset:592
    v_exp_f32 v48, v16
    v_mfma_f32_32x32x16_bf16 v[80:95], v[64:67], v[160:163], v[80:95]
    v_exp_f32 v49, v17
    v_exp_f32 v50, v18
    v_exp_f32 v51, v19
    v_exp_f32 v52, v20
    v_mfma_f32_32x32x16_bf16 v[96:111], v[68:71], v[160:163], v[96:111]
    ds_read_b128 v[160:163], v1 offset:6144
    v_exp_f32 v53, v21
    v_exp_f32 v54, v22
    v_exp_f32 v55, v23
    s_waitcnt lgkmcnt(5)
    v_mfma_f32_32x32x8bf16_1k v[32:47], v[164:165], v[166:167], 0
    v_exp_f32 v56, v24
    v_exp_f32 v57, v25
    v_exp_f32 v58, v26
    v_exp_f32 v59, v27
    s_mov_b32 s3, 143360
    buffer_load_dwordx4 a[48:51], v13, s[36:39], s3 offen offset:0
    buffer_load_dwordx4 a[52:55], v13, s[36:39], s3 offen offset:1024
    v_exp_f32 v60, v28
    v_exp_f32 v61, v29
    v_exp_f32 v62, v30
    v_exp_f32 v63, v31
    v_pk_add_f32 v[48:49], v[48:49], 1.0 op_sel_hi:[1,0]
    v_pk_add_f32 v[50:51], v[50:51], 1.0 op_sel_hi:[1,0]
    v_pk_add_f32 v[52:53], v[52:53], 1.0 op_sel_hi:[1,0]
    v_pk_add_f32 v[54:55], v[54:55], 1.0 op_sel_hi:[1,0]
    v_pk_add_f32 v[56:57], v[56:57], 1.0 op_sel_hi:[1,0]
    v_pk_add_f32 v[58:59], v[58:59], 1.0 op_sel_hi:[1,0]
    v_pk_add_f32 v[60:61], v[60:61], 1.0 op_sel_hi:[1,0]
    v_pk_add_f32 v[62:63], v[62:63], 1.0 op_sel_hi:[1,0]
    s_waitcnt lgkmcnt(1)
    v_mfma_f32_32x32x16_bf16 v[32:47], v[156:159], v[152:155], v[32:47]
    v_rcp_f32 v48, v48
    v_rcp_f32 v49, v49
    v_rcp_f32 v50, v50
    v_rcp_f32 v51, v51
    v_rcp_f32 v52, v52
    v_rcp_f32 v53, v53
    v_rcp_f32 v54, v54
    v_rcp_f32 v55, v55
    v_rcp_f32 v56, v56
    v_rcp_f32 v57, v57
    s_waitcnt vmcnt(12)
    v_mfma_f32_4x4x4bf16_1k v[32:35], v[144:145], v[120:121], v[32:35]
    v_rcp_f32 v58, v58
    buffer_load_dword v120, v72, s[24:27], 0 offen
    buffer_load_dword v121, v73, s[24:27], 0 offen
    v_mfma_f32_4x4x4bf16_1k v[36:39], v[144:145], v[122:123], v[36:39]
    v_rcp_f32 v59, v59
    buffer_load_dword v122, v74, s[24:27], 0 offen
    buffer_load_dword v123, v75, s[24:27], 0 offen
    v_mfma_f32_4x4x4bf16_1k v[40:43], v[144:145], v[124:125], v[40:43]
    v_rcp_f32 v60, v60
    buffer_load_dword v124, v76, s[24:27], 0 offen
    buffer_load_dword v125, v77, s[24:27], 0 offen
    v_mfma_f32_4x4x4bf16_1k v[44:47], v[144:145], v[126:127], v[44:47]
    v_rcp_f32 v61, v61
    buffer_load_dword v126, v78, s[24:27], 0 offen
    buffer_load_dword v127, v79, s[24:27], 0 offen
    v_rcp_f32 v62, v62
    v_rcp_f32 v63, v63
    v_pk_mul_f32 v[48:49], v[48:49], v[16:17]
    v_pk_mul_f32 v[50:51], v[50:51], v[18:19]
    v_pk_mul_f32 v[52:53], v[52:53], v[20:21]
    v_pk_mul_f32 v[54:55], v[54:55], v[22:23]
    v_pk_mul_f32 v[56:57], v[56:57], v[24:25]
    v_pk_mul_f32 v[58:59], v[58:59], v[26:27]
    v_pk_mul_f32 v[60:61], v[60:61], v[28:29]
    v_pk_mul_f32 v[62:63], v[62:63], v[30:31]
    v_cvt_pk_bf16_f32 v64, v48, v50
    v_cvt_pk_bf16_f32 v65, v52, v54
    v_cvt_pk_bf16_f32 v66, v56, v58
    v_cvt_pk_bf16_f32 v67, v60, v62
    v_cvt_pk_bf16_f32 v68, v49, v51
    v_cvt_pk_bf16_f32 v69, v53, v55
    v_cvt_pk_bf16_f32 v70, v57, v59
    v_cvt_pk_bf16_f32 v71, v61, v63
    s_add_u32 s61, s61, 1
    s_cmp_eq_u32 s61, s99
    s_waitcnt lgkmcnt(0)
    s_cbranch_scc1 egnn_edge_kernel_eva6
egnn_edge_kernel_nexta6:
    s_setprio 0
    ds_read_b64 v[164:165], v2 offset:2048
    ds_read_b128 v[156:159], v5
    ds_read_u16 v5, v3 offset:1152
    ds_read_b128 v[72:75], v4 offset:640
    ds_read_b128 v[76:79], v4 offset:656
    v_exp_f32 v48, v32
    v_mfma_f32_32x32x16_bf16 v[80:95], v[64:67], v[160:163], v[80:95]
    v_exp_f32 v49, v33
    v_exp_f32 v50, v34
    v_exp_f32 v51, v35
    v_exp_f32 v52, v36
    v_mfma_f32_32x32x16_bf16 v[96:111], v[68:71], v[160:163], v[96:111]
    ds_read_b128 v[160:163], v1 offset:7168
    v_exp_f32 v53, v37
    v_exp_f32 v54, v38
    v_exp_f32 v55, v39
    s_waitcnt lgkmcnt(5)
    v_mfma_f32_32x32x8bf16_1k v[16:31], v[164:165], v[166:167], 0
    v_exp_f32 v56, v40
    v_exp_f32 v57, v41
    v_exp_f32 v58, v42
    v_exp_f32 v59, v43
    s_mov_b32 s3, 143360
    buffer_load_dwordx4 a[56:59], v13, s[36:39], s3 offen offset:2048
    buffer_load_dwordx4 a[60:63], v13, s[36:39], s3 offen offset:3072
    v_exp_f32 v60, v44
    v_exp_f32 v61, v45
    v_exp_f32 v62, v46
    v_exp_f32 v63, v47
    v_pk_add_f32 v[48:49], v[48:49], 1.0 op_sel_hi:[1,0]
    v_pk_add_f32 v[50:51], v[50:51], 1.0 op_sel_hi:[1,0]
    v_pk_add_f32 v[52:53], v[52:53], 1.0 op_sel_hi:[1,0]
    v_pk_add_f32 v[54:55], v[54:55], 1.0 op_sel_hi:[1,0]
    v_pk_add_f32 v[56:57], v[56:57], 1.0 op_sel_hi:[1,0]
    v_pk_add_f32 v[58:59], v[58:59], 1.0 op_sel_hi:[1,0]
    v_pk_add_f32 v[60:61], v[60:61], 1.0 op_sel_hi:[1,0]
    v_pk_add_f32 v[62:63], v[62:63], 1.0 op_sel_hi:[1,0]
    s_waitcnt lgkmcnt(1)
    v_mfma_f32_32x32x16_bf16 v[16:31], v[156:159], v[152:155], v[16:31]
    v_rcp_f32 v48, v48
    v_rcp_f32 v49, v49
    v_rcp_f32 v50, v50
    v_rcp_f32 v51, v51
    v_rcp_f32 v52, v52
    v_rcp_f32 v53, v53
    v_rcp_f32 v54, v54
    v_rcp_f32 v55, v55
    v_rcp_f32 v56, v56
    v_rcp_f32 v57, v57
    s_waitcnt vmcnt(12)
    v_mfma_f32_4x4x4bf16_1k v[16:19], v[144:145], v[112:113], v[16:19]
    v_rcp_f32 v58, v58
    buffer_load_dword v112, v72, s[24:27], 0 offen
    buffer_load_dword v113, v73, s[24:27], 0 offen
    v_mfma_f32_4x4x4bf16_1k v[20:23], v[144:145], v[114:115], v[20:23]
    v_rcp_f32 v59, v59
    buffer_load_dword v114, v74, s[24:27], 0 offen
    buffer_load_dword v115, v75, s[24:27], 0 offen
    v_mfma_f32_4x4x4bf16_1k v[24:27], v[144:145], v[116:117], v[24:27]
    v_rcp_f32 v60, v60
    buffer_load_dword v116, v76, s[24:27], 0 offen
    buffer_load_dword v117, v77, s[24:27], 0 offen
    v_mfma_f32_4x4x4bf16_1k v[28:31], v[144:145], v[118:119], v[28:31]
    v_rcp_f32 v61, v61
    buffer_load_dword v118, v78, s[24:27], 0 offen
    buffer_load_dword v119, v79, s[24:27], 0 offen
    v_rcp_f32 v62, v62
    v_rcp_f32 v63, v63
    v_pk_mul_f32 v[48:49], v[48:49], v[32:33]
    v_pk_mul_f32 v[50:51], v[50:51], v[34:35]
    v_pk_mul_f32 v[52:53], v[52:53], v[36:37]
    v_pk_mul_f32 v[54:55], v[54:55], v[38:39]
    v_pk_mul_f32 v[56:57], v[56:57], v[40:41]
    v_pk_mul_f32 v[58:59], v[58:59], v[42:43]
    v_pk_mul_f32 v[60:61], v[60:61], v[44:45]
    v_pk_mul_f32 v[62:63], v[62:63], v[46:47]
    v_add_u32 v1, 8192, v1
    v_add_u32 v2, 2048, v2
    v_add_u32 v3, 1024, v3
    v_add_u32 v4, 512, v4
    v_cvt_pk_bf16_f32 v64, v48, v50
    v_cvt_pk_bf16_f32 v65, v52, v54
    v_cvt_pk_bf16_f32 v66, v56, v58
    v_cvt_pk_bf16_f32 v67, v60, v62
    v_cvt_pk_bf16_f32 v68, v49, v51
    v_cvt_pk_bf16_f32 v69, v53, v55
    v_cvt_pk_bf16_f32 v70, v57, v59
    v_cvt_pk_bf16_f32 v71, v61, v63
    s_add_u32 s61, s61, 1
    s_cmp_eq_u32 s61, s99
    s_waitcnt lgkmcnt(0)
    s_cbranch_scc1 egnn_edge_kernel_eva7
egnn_edge_kernel_nexta7:
    s_setprio 3
    ds_read_b64 v[164:165], v2 offset:256
    ds_read_b128 v[128:131], v14 offset:0
    ds_read_b128 v[132:135], v14 offset:8704
    ds_read_b128 v[136:139], v14 offset:17408
    ds_read_b128 v[156:159], v5
    ds_read_u16 v5, v3 offset:256
    ds_read_b128 v[72:75], v4 offset:192
    ds_read_b128 v[76:79], v4 offset:208
    v_exp_f32 v48, v16
    v_mfma_f32_32x32x16_bf16 v[80:95], v[64:67], v[160:163], v[80:95]
    v_exp_f32 v49, v17
    v_exp_f32 v50, v18
    v_exp_f32 v51, v19
    v_exp_f32 v52, v20
    v_mfma_f32_32x32x16_bf16 v[96:111], v[68:71], v[160:163], v[96:111]
    ds_read_b128 v[160:163], v1 offset:0
    v_exp_f32 v53, v21
    v_exp_f32 v54, v22
    v_exp_f32 v55, v23
    s_waitcnt lgkmcnt(5)
    v_mfma_f32_32x32x8bf16_1k v[32:47], v[164:165], v[166:167], 0
    v_exp_f32 v56, v24
    v_exp_f32 v57, v25
    v_exp_f32 v58, v26
    v_mfma_f32_16x16x32_bf16 v[168:171], v[128:131], a[0:3], 0
    v_exp_f32 v59, v27
    v_mfma_f32_16x16x32_bf16 v[172:175], v[128:131], a[4:7], 0
    v_exp_f32 v60, v28
    v_exp_f32 v61, v29
    v_exp_f32 v62, v30
    v_exp_f32 v63, v31
    v_pk_add_f32 v[48:49], v[48:49], 1.0 op_sel_hi:[1,0]
    v_pk_add_f32 v[50:51], v[50:51], 1.0 op_sel_hi:[1,0]
    v_pk_add_f32 v[52:53], v[52:53], 1.0 op_sel_hi:[1,0]
    v_pk_add_f32 v[54:55], v[54:55], 1.0 op_sel_hi:[1,0]
    v_pk_add_f32 v[56:57], v[56:57], 1.0 op_sel_hi:[1,0]
    v_pk_add_f32 v[58:59], v[58:59], 1.0 op_sel_hi:[1,0]
    v_pk_add_f32 v[60:61], v[60:61], 1.0 op_sel_hi:[1,0]
    v_pk_add_f32 v[62:63], v[62:63], 1.0 op_sel_hi:[1,0]
    s_waitcnt lgkmcnt(1)
    v_mfma_f32_32x32x16_bf16 v[32:47], v[156:159], v[152:155], v[32:47]
    v_rcp_f32 v48, v48
    v_rcp_f32 v49, v49
    v_rcp_f32 v50, v50
    v_mfma_f32_16x16x32_bf16 v[176:179], v[132:135], a[0:3], 0
    v_rcp_f32 v51, v51
    v_mfma_f32_16x16x32_bf16 v[180:183], v[132:135], a[4:7], 0
    v_rcp_f32 v52, v52
    v_mfma_f32_16x16x32_bf16 v[184:187], v[136:139], a[0:3], 0
    v_rcp_f32 v53, v53
    v_mfma_f32_16x16x32_bf16 v[188:191], v[136:139], a[4:7], 0
    v_rcp_f32 v54, v54
    s_mov_b32 s3, 262144
    buffer_load_dwordx4 a[0:3], v13, s[36:39], s3 offen offset:0
    buffer_load_dwordx4 a[4:7], v13, s[36:39], s3 offen offset:1024
    v_rcp_f32 v55, v55
    v_rcp_f32 v56, v56
    v_rcp_f32 v57, v57
    s_waitcnt vmcnt(12)
    v_mfma_f32_4x4x4bf16_1k v[32:35], v[144:145], v[120:121], v[32:35]
    v_rcp_f32 v58, v58
    buffer_load_dword v120, v72, s[24:27], 0 offen
    buffer_load_dword v121, v73, s[24:27], 0 offen
    v_mfma_f32_4x4x4bf16_1k v[36:39], v[144:145], v[122:123], v[36:39]
    v_rcp_f32 v59, v59
    buffer_load_dword v122, v74, s[24:27], 0 offen
    buffer_load_dword v123, v75, s[24:27], 0 offen
    v_mfma_f32_4x4x4bf16_1k v[40:43], v[144:145], v[124:125], v[40:43]
    v_rcp_f32 v60, v60
    buffer_load_dword v124, v76, s[24:27], 0 offen
    buffer_load_dword v125, v77, s[24:27], 0 offen
    v_mfma_f32_4x4x4bf16_1k v[44:47], v[144:145], v[126:127], v[44:47]
    v_rcp_f32 v61, v61
    buffer_load_dword v126, v78, s[24:27], 0 offen
    buffer_load_dword v127, v79, s[24:27], 0 offen
    v_rcp_f32 v62, v62
    v_rcp_f32 v63, v63
    v_pk_mul_f32 v[48:49], v[48:49], v[16:17]
    v_pk_mul_f32 v[50:51], v[50:51], v[18:19]
    v_pk_mul_f32 v[52:53], v[52:53], v[20:21]
    v_pk_mul_f32 v[54:55], v[54:55], v[22:23]
    v_pk_mul_f32 v[56:57], v[56:57], v[24:25]
    v_pk_mul_f32 v[58:59], v[58:59], v[26:27]
    v_pk_mul_f32 v[60:61], v[60:61], v[28:29]
    v_pk_mul_f32 v[62:63], v[62:63], v[30:31]
    v_cvt_pk_bf16_f32 v64, v48, v50
    v_cvt_pk_bf16_f32 v65, v52, v54
    v_cvt_pk_bf16_f32 v66, v56, v58
    v_cvt_pk_bf16_f32 v67, v60, v62
    v_cvt_pk_bf16_f32 v68, v49, v51
    v_cvt_pk_bf16_f32 v69, v53, v55
    v_cvt_pk_bf16_f32 v70, v57, v59
    v_cvt_pk_bf16_f32 v71, v61, v63
    s_add_u32 s61, s61, 1
    s_cmp_eq_u32 s61, s99
    s_waitcnt lgkmcnt(0)
    s_cbranch_scc1 egnn_edge_kernel_evb0
egnn_edge_kernel_nextb0:
    s_setprio 2
    ds_read_b64 v[164:165], v2 offset:512
    ds_read_b128 v[128:131], v14 offset:64
    ds_read_b128 v[132:135], v14 offset:8768
    ds_read_b128 v[136:139], v14 offset:17472
    ds_read_b128 v[156:159], v5
    ds_read_u16 v5, v3 offset:384
    ds_read_b128 v[72:75], v4 offset:256
    ds_read_b128 v[76:79], v4 offset:272
    v_exp_f32 v48, v32
    v_mfma_f32_32x32x16_bf16 v[80:95], v[64:67], v[160:163], v[80:95]
    v_exp_f32 v49, v33
    v_exp_f32 v50, v34
    v_exp_f32 v51, v35
    v_exp_f32 v52, v36
    v_mfma_f32_32x32x16_bf16 v[96:111], v[68:71], v[160:163], v[96:111]
    ds_read_b128 v[160:163], v1 offset:1024
    v_exp_f32 v53, v37
    v_exp_f32 v54, v38
    v_exp_f32 v55, v39
    s_waitcnt lgkmcnt(5)
    v_mfma_f32_32x32x8bf16_1k v[16:31], v[164:165], v[166:167], 0
    v_exp_f32 v56, v40
    v_exp_f32 v57, v41
    v_exp_f32 v58, v42
    v_mfma_f32_16x16x32_bf16 v[168:171], v[128:131], a[8:11], v[168:171]
    v_exp_f32 v59, v43
    v_mfma_f32_16x16x32_bf16 v[172:175], v[128:131], a[12:15], v[172:175]
    v_exp_f32 v60, v44
    v_exp_f32 v61, v45
    v_exp_f32 v62, v46
    v_exp_f32 v63, v47
    v_pk_add_f32 v[48:49], v[48:49], 1.0 op_sel_hi:[1,0]
    v_pk_add_f32 v[50:51], v[50:51], 1.0 op_sel_hi:[1,0]
    v_pk_add_f32 v[52:53], v[52:53], 1.0 op_sel_hi:[1,0]
    v_pk_add_f32 v[54:55], v[54:55], 1.0 op_sel_hi:[1,0]
    v_pk_add_f32 v[56:57], v[56:57], 1.0 op_sel_hi:[1,0]
    v_pk_add_f32 v[58:59], v[58:59], 1.0 op_sel_hi:[1,0]
    v_pk_add_f32 v[60:61], v[60:61], 1.0 op_sel_hi:[1,0]
    v_pk_add_f32 v[62:63], v[62:63], 1.0 op_sel_hi:[1,0]
    s_waitcnt lgkmcnt(1)
    v_mfma_f32_32x32x16_bf16 v[16:31], v[156:159], v[152:155], v[16:31]
    v_rcp_f32 v48, v48
    v_rcp_f32 v49, v49
    v_rcp_f32 v50, v50
    v_mfma_f32_16x16x32_bf16 v[176:179], v[132:135], a[8:11], v[176:179]
    v_rcp_f32 v51, v51
    v_mfma_f32_16x16x32_bf16 v[180:183], v[132:135], a[12:15], v[180:183]
    v_rcp_f32 v52, v52
    v_mfma_f32_16x16x32_bf16 v[184:187], v[136:139], a[8:11], v[184:187]
    v_rcp_f32 v53, v53
    v_mfma_f32_16x16x32_bf16 v[188:191], v[136:139], a[12:15], v[188:191]
    v_rcp_f32 v54, v54
    s_mov_b32 s3, 262144
    buffer_load_dwordx4 a[8:11], v13, s[36:39], s3 offen offset:2048
    buffer_load_dwordx4 a[12:15], v13, s[36:39], s3 offen offset:3072
    v_rcp_f32 v55, v55
    v_rcp_f32 v56, v56
    v_rcp_f32 v57, v57
    s_waitcnt vmcnt(12)
    v_mfma_f32_4x4x4bf16_1k v[16:19], v[144:145], v[112:113], v[16:19]
    v_rcp_f32 v58, v58
    buffer_load_dword v112, v72, s[24:27], 0 offen
    buffer_load_dword v113, v73, s[24:27], 0 offen
    v_mfma_f32_4x4x4bf16_1k v[20:23], v[144:145], v[114:115], v[20:23]
    v_rcp_f32 v59, v59
    buffer_load_dword v114, v74, s[24:27], 0 offen
    buffer_load_dword v115, v75, s[24:27], 0 offen
    v_mfma_f32_4x4x4bf16_1k v[24:27], v[144:145], v[116:117], v[24:27]
    v_rcp_f32 v60, v60
    buffer_load_dword v116, v76, s[24:27], 0 offen
    buffer_load_dword v117, v77, s[24:27], 0 offen
    v_mfma_f32_4x4x4bf16_1k v[28:31], v[144:145], v[118:119], v[28:31]
    v_rcp_f32 v61, v61
    buffer_load_dword v118, v78, s[24:27], 0 offen
    buffer_load_dword v119, v79, s[24:27], 0 offen
    v_rcp_f32 v62, v62
    v_rcp_f32 v63, v63
    v_pk_mul_f32 v[48:49], v[48:49], v[32:33]
    v_pk_mul_f32 v[50:51], v[50:51], v[34:35]
    v_pk_mul_f32 v[52:53], v[52:53], v[36:37]
    v_pk_mul_f32 v[54:55], v[54:55], v[38:39]
    v_pk_mul_f32 v[56:57], v[56:57], v[40:41]
    v_pk_mul_f32 v[58:59], v[58:59], v[42:43]
    v_pk_mul_f32 v[60:61], v[60:61], v[44:45]
    v_pk_mul_f32 v[62:63], v[62:63], v[46:47]
    v_cvt_pk_bf16_f32 v64, v48, v50
    v_cvt_pk_bf16_f32 v65, v52, v54
    v_cvt_pk_bf16_f32 v66, v56, v58
    v_cvt_pk_bf16_f32 v67, v60, v62
    v_cvt_pk_bf16_f32 v68, v49, v51
    v_cvt_pk_bf16_f32 v69, v53, v55
    v_cvt_pk_bf16_f32 v70, v57, v59
    v_cvt_pk_bf16_f32 v71, v61, v63
    s_add_u32 s61, s61, 1
    s_cmp_eq_u32 s61, s99
    s_waitcnt lgkmcnt(0)
    s_cbranch_scc1 egnn_edge_kernel_evb1
egnn_edge_kernel_nextb1:
    s_setprio 1
    ds_read_b64 v[164:165], v2 offset:768
    ds_read_b128 v[128:131], v14 offset:128
    ds_read_b128 v[132:135], v14 offset:8832
    ds_read_b128 v[136:139], v14 offset:17536
    ds_read_b128 v[156:159], v5
    ds_read_u16 v5, v3 offset:512
    ds_read_b128 v[72:75], v4 offset:320
    ds_read_b128 v[76:79], v4 offset:336
    v_exp_f32 v48, v16
    v_mfma_f32_32x32x16_bf16 v[80:95], v[64:67], v[160:163], v[80:95]
    v_exp_f32 v49, v17
    v_exp_f32 v50, v18
    v_exp_f32 v51, v19
    v_exp_f32 v52, v20
    v_mfma_f32_32x32x16_bf16 v[96:111], v[68:71], v[160:163], v[96:111]
    ds_read_b128 v[160:163], v1 offset:2048
    v_exp_f32 v53, v21
    v_exp_f32 v54, v22
    v_exp_f32 v55, v23
    s_waitcnt lgkmcnt(5)
    v_mfma_f32_32x32x8bf16_1k v[32:47], v[164:165], v[166:167], 0
    v_exp_f32 v56, v24
    v_exp_f32 v57, v25
    v_exp_f32 v58, v26
    v_mfma_f32_16x16x32_bf16 v[168:171], v[128:131], a[16:19], v[168:171]
    v_exp_f32 v59, v27
    v_mfma_f32_16x16x32_bf16 v[172:175], v[128:131], a[20:23], v[172:175]
    v_exp_f32 v60, v28
    v_exp_f32 v61, v29
    v_exp_f32 v62, v30
    v_exp_f32 v63, v31
    v_pk_add_f32 v[48:49], v[48:49], 1.0 op_sel_hi:[1,0]
    v_pk_add_f32 v[50:51], v[50:51], 1.0 op_sel_hi:[1,0]
    v_pk_add_f32 v[52:53], v[52:53], 1.0 op_sel_hi:[1,0]
    v_pk_add_f32 v[54:55], v[54:55], 1.0 op_sel_hi:[1,0]
    v_pk_add_f32 v[56:57], v[56:57], 1.0 op_sel_hi:[1,0]
    v_pk_add_f32 v[58:59], v[58:59], 1.0 op_sel_hi:[1,0]
    v_pk_add_f32 v[60:61], v[60:61], 1.0 op_sel_hi:[1,0]
    v_pk_add_f32 v[62:63], v[62:63], 1.0 op_sel_hi:[1,0]
    s_waitcnt lgkmcnt(1)
    v_mfma_f32_32x32x16_bf16 v[32:47], v[156:159], v[152:155], v[32:47]
    v_rcp_f32 v48, v48
    v_rcp_f32 v49, v49
    v_rcp_f32 v50, v50
    v_mfma_f32_16x16x32_bf16 v[176:179], v[132:135], a[16:19], v[176:179]
    v_rcp_f32 v51, v51
    v_mfma_f32_16x16x32_bf16 v[180:183], v[132:135], a[20:23], v[180:183]
    v_rcp_f32 v52, v52
    v_mfma_f32_16x16x32_bf16 v[184:187], v[136:139], a[16:19], v[184:187]
    v_rcp_f32 v53, v53
    v_mfma_f32_16x16x32_bf16 v[188:191], v[136:139], a[20:23], v[188:191]
    v_rcp_f32 v54, v54
    s_mov_b32 s3, 266240
    buffer_load_dwordx4 a[16:19], v13, s[36:39], s3 offen offset:0
    buffer_load_dwordx4 a[20:23], v13, s[36:39], s3 offen offset:1024
    v_rcp_f32 v55, v55
    v_rcp_f32 v56, v56
    v_rcp_f32 v57, v57
    s_waitcnt vmcnt(12)
    v_mfma_f32_4x4x4bf16_1k v[32:35], v[144:145], v[120:121], v[32:35]
    v_rcp_f32 v58, v58
    buffer_load_dword v120, v72, s[24:27], 0 offen
    buffer_load_dword v121, v73, s[24:27], 0 offen
    v_mfma_f32_4x4x4bf16_1k v[36:39], v[144:145], v[122:123], v[36:39]
    v_rcp_f32 v59, v59
    buffer_load_dword v122, v74, s[24:27], 0 offen
    buffer_load_dword v123, v75, s[24:27], 0 offen
    v_mfma_f32_4x4x4bf16_1k v[40:43], v[144:145], v[124:125], v[40:43]
    v_rcp_f32 v60, v60
    buffer_load_dword v124, v76, s[24:27], 0 offen
    buffer_load_dword v125, v77, s[24:27], 0 offen
    v_mfma_f32_4x4x4bf16_1k v[44:47], v[144:145], v[126:127], v[44:47]
    v_rcp_f32 v61, v61
    buffer_load_dword v126, v78, s[24:27], 0 offen
    buffer_load_dword v127, v79, s[24:27], 0 offen
    v_rcp_f32 v62, v62
    v_rcp_f32 v63, v63
    v_pk_mul_f32 v[48:49], v[48:49], v[16:17]
    v_pk_mul_f32 v[50:51], v[50:51], v[18:19]
    v_pk_mul_f32 v[52:53], v[52:53], v[20:21]
    v_pk_mul_f32 v[54:55], v[54:55], v[22:23]
    v_pk_mul_f32 v[56:57], v[56:57], v[24:25]
    v_pk_mul_f32 v[58:59], v[58:59], v[26:27]
    v_pk_mul_f32 v[60:61], v[60:61], v[28:29]
    v_pk_mul_f32 v[62:63], v[62:63], v[30:31]
    v_cvt_pk_bf16_f32 v64, v48, v50
    v_cvt_pk_bf16_f32 v65, v52, v54
    v_cvt_pk_bf16_f32 v66, v56, v58
    v_cvt_pk_bf16_f32 v67, v60, v62
    v_cvt_pk_bf16_f32 v68, v49, v51
    v_cvt_pk_bf16_f32 v69, v53, v55
    v_cvt_pk_bf16_f32 v70, v57, v59
    v_cvt_pk_bf16_f32 v71, v61, v63
    s_add_u32 s61, s61, 1
    s_cmp_eq_u32 s61, s99
    s_waitcnt lgkmcnt(0)
    s_cbranch_scc1 egnn_edge_kernel_evb2
egnn_edge_kernel_nextb2:
    s_setprio 0
    ds_read_b64 v[164:165], v2 offset:1024
    ds_read_b128 v[128:131], v14 offset:192
    ds_read_b128 v[132:135], v14 offset:8896
    ds_read_b128 v[136:139], v14 offset:17600
    ds_read_b128 v[156:159], v5
    ds_read_u16 v5, v3 offset:640
    ds_read_b128 v[72:75], v4 offset:384
    ds_read_b128 v[76:79], v4 offset:400
    v_exp_f32 v48, v32
    v_mfma_f32_32x32x16_bf16 v[80:95], v[64:67], v[160:163], v[80:95]
    v_exp_f32 v49, v33
    v_exp_f32 v50, v34
    v_exp_f32 v51, v35
    v_exp_f32 v52, v36
    v_mfma_f32_32x32x16_bf16 v[96:111], v[68:71], v[160:163], v[96:111]
    ds_read_b128 v[160:163], v1 offset:3072
    v_exp_f32 v53, v37
    v_exp_f32 v54, v38
    v_exp_f32 v55, v39
    s_waitcnt lgkmcnt(5)
    v_mfma_f32_32x32x8bf16_1k v[16:31], v[164:165], v[166:167], 0
    v_exp_f32 v56, v40
    v_exp_f32 v57, v41
    v_exp_f32 v58, v42
    v_mfma_f32_16x16x32_bf16 v[168:171], v[128:131], a[24:27], v[168:171]
    v_exp_f32 v59, v43
    v_mfma_f32_16x16x32_bf16 v[172:175], v[128:131], a[28:31], v[172:175]
    v_exp_f32 v60, v44
    v_exp_f32 v61, v45
    v_exp_f32 v62, v46
    v_exp_f32 v63, v47
    v_pk_add_f32 v[48:49], v[48:49], 1.0 op_sel_hi:[1,0]
    v_pk_add_f32 v[50:51], v[50:51], 1.0 op_sel_hi:[1,0]
    v_pk_add_f32 v[52:53], v[52:53], 1.0 op_sel_hi:[1,0]
    v_pk_add_f32 v[54:55], v[54:55], 1.0 op_sel_hi:[1,0]
    v_pk_add_f32 v[56:57], v[56:57], 1.0 op_sel_hi:[1,0]
    v_pk_add_f32 v[58:59], v[58:59], 1.0 op_sel_hi:[1,0]
    v_pk_add_f32 v[60:61], v[60:61], 1.0 op_sel_hi:[1,0]
    v_pk_add_f32 v[62:63], v[62:63], 1.0 op_sel_hi:[1,0]
    s_waitcnt lgkmcnt(1)
    v_mfma_f32_32x32x16_bf16 v[16:31], v[156:159], v[152:155], v[16:31]
    v_rcp_f32 v48, v48
    v_rcp_f32 v49, v49
    v_rcp_f32 v50, v50
    v_mfma_f32_16x16x32_bf16 v[176:179], v[132:135], a[24:27], v[176:179]
    v_rcp_f32 v51, v51
    v_mfma_f32_16x16x32_bf16 v[180:183], v[132:135], a[28:31], v[180:183]
    v_rcp_f32 v52, v52
    v_mfma_f32_16x16x32_bf16 v[184:187], v[136:139], a[24:27], v[184:187]
    v_rcp_f32 v53, v53
    v_mfma_f32_16x16x32_bf16 v[188:191], v[136:139], a[28:31], v[188:191]
    v_rcp_f32 v54, v54
    s_mov_b32 s3, 266240
    buffer_load_dwordx4 a[24:27], v13, s[36:39], s3 offen offset:2048
    buffer_load_dwordx4 a[28:31], v13, s[36:39], s3 offen offset:3072
    v_rcp_f32 v55, v55
    v_rcp_f32 v56, v56
    v_rcp_f32 v57, v57
    s_waitcnt vmcnt(12)
    v_mfma_f32_4x4x4bf16_1k v[16:19], v[144:145], v[112:113], v[16:19]
    v_rcp_f32 v58, v58
    buffer_load_dword v112, v72, s[24:27], 0 offen
    buffer_load_dword v113, v73, s[24:27], 0 offen
    v_mfma_f32_4x4x4bf16_1k v[20:23], v[144:145], v[114:115], v[20:23]
    v_rcp_f32 v59, v59
    buffer_load_dword v114, v74, s[24:27], 0 offen
    buffer_load_dword v115, v75, s[24:27], 0 offen
    v_mfma_f32_4x4x4bf16_1k v[24:27], v[144:145], v[116:117], v[24:27]
    v_rcp_f32 v60, v60
    buffer_load_dword v116, v76, s[24:27], 0 offen
    buffer_load_dword v117, v77, s[24:27], 0 offen
    v_mfma_f32_4x4x4bf16_1k v[28:31], v[144:145], v[118:119], v[28:31]
    v_rcp_f32 v61, v61
    buffer_load_dword v118, v78, s[24:27], 0 offen
    buffer_load_dword v119, v79, s[24:27], 0 offen
    v_rcp_f32 v62, v62
    v_rcp_f32 v63, v63
    v_pk_mul_f32 v[48:49], v[48:49], v[32:33]
    v_pk_mul_f32 v[50:51], v[50:51], v[34:35]
    v_pk_mul_f32 v[52:53], v[52:53], v[36:37]
    v_pk_mul_f32 v[54:55], v[54:55], v[38:39]
    v_pk_mul_f32 v[56:57], v[56:57], v[40:41]
    v_pk_mul_f32 v[58:59], v[58:59], v[42:43]
    v_pk_mul_f32 v[60:61], v[60:61], v[44:45]
    v_pk_mul_f32 v[62:63], v[62:63], v[46:47]
    v_cvt_pk_bf16_f32 v64, v48, v50
    v_cvt_pk_bf16_f32 v65, v52, v54
    v_cvt_pk_bf16_f32 v66, v56, v58
    v_cvt_pk_bf16_f32 v67, v60, v62
    v_cvt_pk_bf16_f32 v68, v49, v51
    v_cvt_pk_bf16_f32 v69, v53, v55
    v_cvt_pk_bf16_f32 v70, v57, v59
    v_cvt_pk_bf16_f32 v71, v61, v63
    s_add_u32 s61, s61, 1
    s_cmp_eq_u32 s61, s99
    s_waitcnt lgkmcnt(0)
    s_cbranch_scc1 egnn_edge_kernel_evb3
egnn_edge_kernel_nextb3:
    s_setprio 3
    ds_read_b64 v[164:165], v2 offset:1280
    ds_read_b128 v[128:131], v14 offset:256
    ds_read_b128 v[132:135], v14 offset:8960
    ds_read_b128 v[136:139], v14 offset:17664
    ds_read_b128 v[156:159], v5
    ds_read_u16 v5, v3 offset:768
    ds_read_b128 v[72:75], v4 offset:448
    ds_read_b128 v[76:79], v4 offset:464
    v_exp_f32 v48, v16
    v_mfma_f32_32x32x16_bf16 v[80:95], v[64:67], v[160:163], v[80:95]
    v_exp_f32 v49, v17
    v_exp_f32 v50, v18
    v_exp_f32 v51, v19
    v_exp_f32 v52, v20
    v_mfma_f32_32x32x16_bf16 v[96:111], v[68:71], v[160:163], v[96:111]
    ds_read_b128 v[160:163], v1 offset:4096
    v_exp_f32 v53, v21
    v_exp_f32 v54, v22
    v_exp_f32 v55, v23
    s_waitcnt lgkmcnt(5)
    v_mfma_f32_32x32x8bf16_1k v[32:47], v[164:165], v[166:167], 0
    v_exp_f32 v56, v24
    v_exp_f32 v57, v25
    v_exp_f32 v58, v26
    v_mfma_f32_16x16x32_bf16 v[168:171], v[128:131], a[32:35], v[168:171]
    v_exp_f32 v59, v27
    v_mfma_f32_16x16x32_bf16 v[172:175], v[128:131], a[36:39], v[172:175]
    v_exp_f32 v60, v28
    v_exp_f32 v61, v29
    v_exp_f32 v62, v30
    v_exp_f32 v63, v31
    v_pk_add_f32 v[48:49], v[48:49], 1.0 op_sel_hi:[1,0]
    v_pk_add_f32 v[50:51], v[50:51], 1.0 op_sel_hi:[1,0]
    v_pk_add_f32 v[52:53], v[52:53], 1.0 op_sel_hi:[1,0]
    v_pk_add_f32 v[54:55], v[54:55], 1.0 op_sel_hi:[1,0]
    v_pk_add_f32 v[56:57], v[56:57], 1.0 op_sel_hi:[1,0]
    v_pk_add_f32 v[58:59], v[58:59], 1.0 op_sel_hi:[1,0]
    v_pk_add_f32 v[60:61], v[60:61], 1.0 op_sel_hi:[1,0]
    v_pk_add_f32 v[62:63], v[62:63], 1.0 op_sel_hi:[1,0]
    s_waitcnt lgkmcnt(1)
    v_mfma_f32_32x32x16_bf16 v[32:47], v[156:159], v[152:155], v[32:47]
    v_rcp_f32 v48, v48
    v_rcp_f32 v49, v49
    v_rcp_f32 v50, v50
    v_mfma_f32_16x16x32_bf16 v[176:179], v[132:135], a[32:35], v[176:179]
    v_rcp_f32 v51, v51
    v_mfma_f32_16x16x32_bf16 v[180:183], v[132:135], a[36:39], v[180:183]
    v_rcp_f32 v52, v52
    v_mfma_f32_16x16x32_bf16 v[184:187], v[136:139], a[32:35], v[184:187]
    v_rcp_f32 v53, v53
    v_mfma_f32_16x16x32_bf16 v[188:191], v[136:139], a[36:39], v[188:191]
    v_rcp_f32 v54, v54
    s_mov_b32 s3, 270336
    buffer_load_dwordx4 a[32:35], v13, s[36:39], s3 offen offset:0
    buffer_load_dwordx4 a[36:39], v13, s[36:39], s3 offen offset:1024
    v_rcp_f32 v55, v55
    v_rcp_f32 v56, v56
    v_rcp_f32 v57, v57
    s_waitcnt vmcnt(12)
    v_mfma_f32_4x4x4bf16_1k v[32:35], v[144:145], v[120:121], v[32:35]
    v_rcp_f32 v58, v58
    buffer_load_dword v120, v72, s[24:27], 0 offen
    buffer_load_dword v121, v73, s[24:27], 0 offen
    v_mfma_f32_4x4x4bf16_1k v[36:39], v[144:145], v[122:123], v[36:39]
    v_rcp_f32 v59, v59
    buffer_load_dword v122, v74, s[24:27], 0 offen
    buffer_load_dword v123, v75, s[24:27], 0 offen
    v_mfma_f32_4x4x4bf16_1k v[40:43], v[144:145], v[124:125], v[40:43]
    v_rcp_f32 v60, v60
    buffer_load_dword v124, v76, s[24:27], 0 offen
    buffer_load_dword v125, v77, s[24:27], 0 offen
    v_mfma_f32_4x4x4bf16_1k v[44:47], v[144:145], v[126:127], v[44:47]
    v_rcp_f32 v61, v61
    buffer_load_dword v126, v78, s[24:27], 0 offen
    buffer_load_dword v127, v79, s[24:27], 0 offen
    v_rcp_f32 v62, v62
    v_rcp_f32 v63, v63
    v_pk_mul_f32 v[48:49], v[48:49], v[16:17]
    v_pk_mul_f32 v[50:51], v[50:51], v[18:19]
    v_pk_mul_f32 v[52:53], v[52:53], v[20:21]
    v_pk_mul_f32 v[54:55], v[54:55], v[22:23]
    v_pk_mul_f32 v[56:57], v[56:57], v[24:25]
    v_pk_mul_f32 v[58:59], v[58:59], v[26:27]
    v_pk_mul_f32 v[60:61], v[60:61], v[28:29]
    v_pk_mul_f32 v[62:63], v[62:63], v[30:31]
    v_cvt_pk_bf16_f32 v64, v48, v50
    v_cvt_pk_bf16_f32 v65, v52, v54
    v_cvt_pk_bf16_f32 v66, v56, v58
    v_cvt_pk_bf16_f32 v67, v60, v62
    v_cvt_pk_bf16_f32 v68, v49, v51
    v_cvt_pk_bf16_f32 v69, v53, v55
    v_cvt_pk_bf16_f32 v70, v57, v59
    v_cvt_pk_bf16_f32 v71, v61, v63
    s_add_u32 s61, s61, 1
    s_cmp_eq_u32 s61, s99
    s_waitcnt lgkmcnt(0)
    s_cbranch_scc1 egnn_edge_kernel_evb4
egnn_edge_kernel_nextb4:
    s_setprio 2
    ds_read_b64 v[164:165], v2 offset:1536
    ds_read_b128 v[128:131], v14 offset:320
    ds_read_b128 v[132:135], v14 offset:9024
    ds_read_b128 v[136:139], v14 offset:17728
    ds_read_b128 v[156:159], v5
    ds_read_u16 v5, v3 offset:896
    ds_read_b128 v[72:75], v4 offset:512
    ds_read_b128 v[76:79], v4 offset:528
    v_exp_f32 v48, v32
    v_mfma_f32_32x32x16_bf16 v[80:95], v[64:67], v[160:163], v[80:95]
    v_exp_f32 v49, v33
    v_exp_f32 v50, v34
    v_exp_f32 v51, v35
    v_exp_f32 v52, v36
    v_mfma_f32_32x32x16_bf16 v[96:111], v[68:71], v[160:163], v[96:111]
    ds_read_b128 v[160:163], v1 offset:5120
    v_exp_f32 v53, v37
    v_exp_f32 v54, v38
    v_exp_f32 v55, v39
    s_waitcnt lgkmcnt(5)
    v_mfma_f32_32x32x8bf16_1k v[16:31], v[164:165], v[166:167], 0
    v_exp_f32 v56, v40
    v_exp_f32 v57, v41
    v_exp_f32 v58, v42
    v_mfma_f32_16x16x32_bf16 v[168:171], v[128:131], a[40:43], v[168:171]
    v_exp_f32 v59, v43
    v_mfma_f32_16x16x32_bf16 v[172:175], v[128:131], a[44:47], v[172:175]
    v_exp_f32 v60, v44
    v_exp_f32 v61, v45
    v_exp_f32 v62, v46
    v_exp_f32 v63, v47
    v_pk_add_f32 v[48:49], v[48:49], 1.0 op_sel_hi:[1,0]
    v_pk_add_f32 v[50:51], v[50:51], 1.0 op_sel_hi:[1,0]
    v_pk_add_f32 v[52:53], v[52:53], 1.0 op_sel_hi:[1,0]
    v_pk_add_f32 v[54:55], v[54:55], 1.0 op_sel_hi:[1,0]
    v_pk_add_f32 v[56:57], v[56:57], 1.0 op_sel_hi:[1,0]
    v_pk_add_f32 v[58:59], v[58:59], 1.0 op_sel_hi:[1,0]
    v_pk_add_f32 v[60:61], v[60:61], 1.0 op_sel_hi:[1,0]
    v_pk_add_f32 v[62:63], v[62:63], 1.0 op_sel_hi:[1,0]
    s_waitcnt lgkmcnt(1)
    v_mfma_f32_32x32x16_bf16 v[16:31], v[156:159], v[152:155], v[16:31]
    v_rcp_f32 v48, v48
    v_rcp_f32 v49, v49
    v_rcp_f32 v50, v50
    v_mfma_f32_16x16x32_bf16 v[176:179], v[132:135], a[40:43], v[176:179]
    v_rcp_f32 v51, v51
    v_mfma_f32_16x16x32_bf16 v[180:183], v[132:135], a[44:47], v[180:183]
    v_rcp_f32 v52, v52
    v_mfma_f32_16x16x32_bf16 v[184:187], v[136:139], a[40:43], v[184:187]
    v_rcp_f32 v53, v53
    v_mfma_f32_16x16x32_bf16 v[188:191], v[136:139], a[44:47], v[188:191]
    v_rcp_f32 v54, v54
    s_mov_b32 s3, 270336
    buffer_load_dwordx4 a[40:43], v13, s[36:39], s3 offen offset:2048
    buffer_load_dwordx4 a[44:47], v13, s[36:39], s3 offen offset:3072
    v_rcp_f32 v55, v55
    v_rcp_f32 v56, v56
    v_rcp_f32 v57, v57
    s_waitcnt vmcnt(12)
    v_mfma_f32_4x4x4bf16_1k v[16:19], v[144:145], v[112:113], v[16:19]
    v_rcp_f32 v58, v58
    buffer_load_dword v112, v72, s[24:27], 0 offen
    buffer_load_dword v113, v73, s[24:27], 0 offen
    v_mfma_f32_4x4x4bf16_1k v[20:23], v[144:145], v[114:115], v[20:23]
    v_rcp_f32 v59, v59
    buffer_load_dword v114, v74, s[24:27], 0 offen
    buffer_load_dword v115, v75, s[24:27], 0 offen
    v_mfma_f32_4x4x4bf16_1k v[24:27], v[144:145], v[116:117], v[24:27]
    v_rcp_f32 v60, v60
    buffer_load_dword v116, v76, s[24:27], 0 offen
    buffer_load_dword v117, v77, s[24:27], 0 offen
    v_mfma_f32_4x4x4bf16_1k v[28:31], v[144:145], v[118:119], v[28:31]
    v_rcp_f32 v61, v61
    buffer_load_dword v118, v78, s[24:27], 0 offen
    buffer_load_dword v119, v79, s[24:27], 0 offen
    v_rcp_f32 v62, v62
    v_rcp_f32 v63, v63
    v_pk_mul_f32 v[48:49], v[48:49], v[32:33]
    v_pk_mul_f32 v[50:51], v[50:51], v[34:35]
    v_pk_mul_f32 v[52:53], v[52:53], v[36:37]
    v_pk_mul_f32 v[54:55], v[54:55], v[38:39]
    v_pk_mul_f32 v[56:57], v[56:57], v[40:41]
    v_pk_mul_f32 v[58:59], v[58:59], v[42:43]
    v_pk_mul_f32 v[60:61], v[60:61], v[44:45]
    v_pk_mul_f32 v[62:63], v[62:63], v[46:47]
    v_cvt_pk_bf16_f32 v64, v48, v50
    v_cvt_pk_bf16_f32 v65, v52, v54
    v_cvt_pk_bf16_f32 v66, v56, v58
    v_cvt_pk_bf16_f32 v67, v60, v62
    v_cvt_pk_bf16_f32 v68, v49, v51
    v_cvt_pk_bf16_f32 v69, v53, v55
    v_cvt_pk_bf16_f32 v70, v57, v59
    v_cvt_pk_bf16_f32 v71, v61, v63
    s_add_u32 s61, s61, 1
    s_cmp_eq_u32 s61, s99
    s_waitcnt lgkmcnt(0)
    s_cbranch_scc1 egnn_edge_kernel_evb5
egnn_edge_kernel_nextb5:
    s_setprio 1
    ds_read_b64 v[164:165], v2 offset:1792
    ds_read_b128 v[128:131], v14 offset:384
    ds_read_b128 v[132:135], v14 offset:9088
    ds_read_b128 v[136:139], v14 offset:17792
    ds_read_b128 v[156:159], v5
    ds_read_u16 v5, v3 offset:1024
    ds_read_b128 v[72:75], v4 offset:576
    ds_read_b128 v[76:79], v4 offset:592
    v_exp_f32 v48, v16
    v_mfma_f32_32x32x16_bf16 v[80:95], v[64:67], v[160:163], v[80:95]
    v_exp_f32 v49, v17
    v_exp_f32 v50, v18
    v_exp_f32 v51, v19
    v_exp_f32 v52, v20
    v_mfma_f32_32x32x16_bf16 v[96:111], v[68:71], v[160:163], v[96:111]
    ds_read_b128 v[160:163], v1 offset:6144
    v_exp_f32 v53, v21
    v_exp_f32 v54, v22
    v_exp_f32 v55, v23
    s_waitcnt lgkmcnt(5)
    v_mfma_f32_32x32x8bf16_1k v[32:47], v[164:165], v[166:167], 0
    v_exp_f32 v56, v24
    v_exp_f32 v57, v25
    v_exp_f32 v58, v26
    v_mfma_f32_16x16x32_bf16 v[168:171], v[128:131], a[48:51], v[168:171]
    v_exp_f32 v59, v27
    v_mfma_f32_16x16x32_bf16 v[172:175], v[128:131], a[52:55], v[172:175]
    v_exp_f32 v60, v28
    v_exp_f32 v61, v29
    v_exp_f32 v62, v30
    v_exp_f32 v63, v31
    v_pk_add_f32 v[48:49], v[48:49], 1.0 op_sel_hi:[1,0]
    v_pk_add_f32 v[50:51], v[50:51], 1.0 op_sel_hi:[1,0]
    v_pk_add_f32 v[52:53], v[52:53], 1.0 op_sel_hi:[1,0]
    v_pk_add_f32 v[54:55], v[54:55], 1.0 op_sel_hi:[1,0]
    v_pk_add_f32 v[56:57], v[56:57], 1.0 op_sel_hi:[1,0]
    v_pk_add_f32 v[58:59], v[58:59], 1.0 op_sel_hi:[1,0]
    v_pk_add_f32 v[60:61], v[60:61], 1.0 op_sel_hi:[1,0]
    v_pk_add_f32 v[62:63], v[62:63], 1.0 op_sel_hi:[1,0]
    s_waitcnt lgkmcnt(1)
    v_mfma_f32_32x32x16_bf16 v[32:47], v[156:159], v[152:155], v[32:47]
    v_rcp_f32 v48, v48
    v_rcp_f32 v49, v49
    v_rcp_f32 v50, v50
    v_mfma_f32_16x16x32_bf16 v[176:179], v[132:135], a[48:51], v[176:179]
    v_rcp_f32 v51, v51
    v_mfma_f32_16x16x32_bf16 v[180:183], v[132:135], a[52:55], v[180:183]
    v_rcp_f32 v52, v52
    v_mfma_f32_16x16x32_bf16 v[184:187], v[136:139], a[48:51], v[184:187]
    v_rcp_f32 v53, v53
    v_mfma_f32_16x16x32_bf16 v[188:191], v[136:139], a[52:55], v[188:191]
    v_rcp_f32 v54, v54
    s_mov_b32 s3, 274432
    buffer_load_dwordx4 a[48:51], v13, s[36:39], s3 offen offset:0
    buffer_load_dwordx4 a[52:55], v13, s[36:39], s3 offen offset:1024
    v_rcp_f32 v55, v55
    v_rcp_f32 v56, v56
    v_rcp_f32 v57, v57
    s_waitcnt vmcnt(12)
    v_mfma_f32_4x4x4bf16_1k v[32:35], v[144:145], v[120:121], v[32:35]
    v_rcp_f32 v58, v58
    buffer_load_dword v120, v72, s[24:27], 0 offen
    buffer_load_dword v121, v73, s[24:27], 0 offen
    v_mfma_f32_4x4x4bf16_1k v[36:39], v[144:145], v[122:123], v[36:39]
    v_rcp_f32 v59, v59
    buffer_load_dword v122, v74, s[24:27], 0 offen
    buffer_load_dword v123, v75, s[24:27], 0 offen
    v_mfma_f32_4x4x4bf16_1k v[40:43], v[144:145], v[124:125], v[40:43]
    v_rcp_f32 v60, v60
    buffer_load_dword v124, v76, s[24:27], 0 offen
    buffer_load_dword v125, v77, s[24:27], 0 offen
    v_mfma_f32_4x4x4bf16_1k v[44:47], v[144:145], v[126:127], v[44:47]
    v_rcp_f32 v61, v61
    buffer_load_dword v126, v78, s[24:27], 0 offen
    buffer_load_dword v127, v79, s[24:27], 0 offen
    v_rcp_f32 v62, v62
    v_rcp_f32 v63, v63
    v_pk_mul_f32 v[48:49], v[48:49], v[16:17]
    v_pk_mul_f32 v[50:51], v[50:51], v[18:19]
    v_pk_mul_f32 v[52:53], v[52:53], v[20:21]
    v_pk_mul_f32 v[54:55], v[54:55], v[22:23]
    v_pk_mul_f32 v[56:57], v[56:57], v[24:25]
    v_pk_mul_f32 v[58:59], v[58:59], v[26:27]
    v_pk_mul_f32 v[60:61], v[60:61], v[28:29]
    v_pk_mul_f32 v[62:63], v[62:63], v[30:31]
    v_cvt_pk_bf16_f32 v64, v48, v50
    v_cvt_pk_bf16_f32 v65, v52, v54
    v_cvt_pk_bf16_f32 v66, v56, v58
    v_cvt_pk_bf16_f32 v67, v60, v62
    v_cvt_pk_bf16_f32 v68, v49, v51
    v_cvt_pk_bf16_f32 v69, v53, v55
    v_cvt_pk_bf16_f32 v70, v57, v59
    v_cvt_pk_bf16_f32 v71, v61, v63
    s_add_u32 s61, s61, 1
    s_cmp_eq_u32 s61, s99
    s_waitcnt lgkmcnt(0)
    s_cbranch_scc1 egnn_edge_kernel_evb6
egnn_edge_kernel_nextb6:
    s_setprio 0
    ds_read_b64 v[164:165], v2 offset:2048
    ds_read_b128 v[128:131], v14 offset:448
    ds_read_b128 v[132:135], v14 offset:9152
    ds_read_b128 v[136:139], v14 offset:17856
    ds_read_b128 v[156:159], v5
    ds_read_u16 v5, v3 offset:1152
    ds_read_b128 v[72:75], v4 offset:640
    ds_read_b128 v[76:79], v4 offset:656
    v_exp_f32 v48, v32
    v_mfma_f32_32x32x16_bf16 v[80:95], v[64:67], v[160:163], v[80:95]
    v_exp_f32 v49, v33
    v_exp_f32 v50, v34
    v_exp_f32 v51, v35
    v_exp_f32 v52, v36
    v_mfma_f32_32x32x16_bf16 v[96:111], v[68:71], v[160:163], v[96:111]
    ds_read_b128 v[160:163], v1 offset:7168
    v_exp_f32 v53, v37
    v_exp_f32 v54, v38
    v_exp_f32 v55, v39
    s_waitcnt lgkmcnt(5)
    v_mfma_f32_32x32x8bf16_1k v[16:31], v[164:165], v[166:167], 0
    v_exp_f32 v56, v40
    v_exp_f32 v57, v41
    v_exp_f32 v58, v42
    v_mfma_f32_16x16x32_bf16 v[168:171], v[128:131], a[56:59], v[168:171]
    v_exp_f32 v59, v43
    v_mfma_f32_16x16x32_bf16 v[172:175], v[128:131], a[60:63], v[172:175]
    v_exp_f32 v60, v44
    v_exp_f32 v61, v45
    v_exp_f32 v62, v46
    v_exp_f32 v63, v47
    v_pk_add_f32 v[48:49], v[48:49], 1.0 op_sel_hi:[1,0]
    v_pk_add_f32 v[50:51], v[50:51], 1.0 op_sel_hi:[1,0]
    v_pk_add_f32 v[52:53], v[52:53], 1.0 op_sel_hi:[1,0]
    v_pk_add_f32 v[54:55], v[54:55], 1.0 op_sel_hi:[1,0]
    v_pk_add_f32 v[56:57], v[56:57], 1.0 op_sel_hi:[1,0]
    v_pk_add_f32 v[58:59], v[58:59], 1.0 op_sel_hi:[1,0]
    v_pk_add_f32 v[60:61], v[60:61], 1.0 op_sel_hi:[1,0]
    v_pk_add_f32 v[62:63], v[62:63], 1.0 op_sel_hi:[1,0]
    s_waitcnt lgkmcnt(1)
    v_mfma_f32_32x32x16_bf16 v[16:31], v[156:159], v[152:155], v[16:31]
    v_rcp_f32 v48, v48
    v_rcp_f32 v49, v49
    v_rcp_f32 v50, v50
    v_mfma_f32_16x16x32_bf16 v[176:179], v[132:135], a[56:59], v[176:179]
    v_rcp_f32 v51, v51
    v_mfma_f32_16x16x32_bf16 v[180:183], v[132:135], a[60:63], v[180:183]
    v_rcp_f32 v52, v52
    v_mfma_f32_16x16x32_bf16 v[184:187], v[136:139], a[56:59], v[184:187]
    v_rcp_f32 v53, v53
    v_mfma_f32_16x16x32_bf16 v[188:191], v[136:139], a[60:63], v[188:191]
    v_rcp_f32 v54, v54
    s_mov_b32 s3, 274432
    buffer_load_dwordx4 a[56:59], v13, s[36:39], s3 offen offset:2048
    buffer_load_dwordx4 a[60:63], v13, s[36:39], s3 offen offset:3072
    v_rcp_f32 v55, v55
    v_rcp_f32 v56, v56
    v_rcp_f32 v57, v57
    s_waitcnt vmcnt(12)
    v_mfma_f32_4x4x4bf16_1k v[16:19], v[144:145], v[112:113], v[16:19]
    v_rcp_f32 v58, v58
    buffer_load_dword v112, v72, s[24:27], 0 offen
    buffer_load_dword v113, v73, s[24:27], 0 offen
    v_mfma_f32_4x4x4bf16_1k v[20:23], v[144:145], v[114:115], v[20:23]
    v_rcp_f32 v59, v59
    buffer_load_dword v114, v74, s[24:27], 0 offen
    buffer_load_dword v115, v75, s[24:27], 0 offen
    v_mfma_f32_4x4x4bf16_1k v[24:27], v[144:145], v[116:117], v[24:27]
    v_rcp_f32 v60, v60
    buffer_load_dword v116, v76, s[24:27], 0 offen
    buffer_load_dword v117, v77, s[24:27], 0 offen
    v_mfma_f32_4x4x4bf16_1k v[28:31], v[144:145], v[118:119], v[28:31]
    v_rcp_f32 v61, v61
    buffer_load_dword v118, v78, s[24:27], 0 offen
    buffer_load_dword v119, v79, s[24:27], 0 offen
    v_rcp_f32 v62, v62
    v_rcp_f32 v63, v63
    v_pk_mul_f32 v[48:49], v[48:49], v[32:33]
    v_pk_mul_f32 v[50:51], v[50:51], v[34:35]
    v_pk_mul_f32 v[52:53], v[52:53], v[36:37]
    v_pk_mul_f32 v[54:55], v[54:55], v[38:39]
    v_pk_mul_f32 v[56:57], v[56:57], v[40:41]
    v_pk_mul_f32 v[58:59], v[58:59], v[42:43]
    v_pk_mul_f32 v[60:61], v[60:61], v[44:45]
    v_pk_mul_f32 v[62:63], v[62:63], v[46:47]
    v_add_u32 v1, 8192, v1
    v_add_u32 v2, 2048, v2
    v_add_u32 v3, 1024, v3
    v_add_u32 v4, 512, v4
    s_add_u32 s65, s65, 1
    v_cvt_pk_bf16_f32 v64, v48, v50
    v_cvt_pk_bf16_f32 v65, v52, v54
    v_cvt_pk_bf16_f32 v66, v56, v58
    v_cvt_pk_bf16_f32 v67, v60, v62
    v_cvt_pk_bf16_f32 v68, v49, v51
    v_cvt_pk_bf16_f32 v69, v53, v55
    v_cvt_pk_bf16_f32 v70, v57, v59
    v_cvt_pk_bf16_f32 v71, v61, v63
    s_add_u32 s61, s61, 1
    s_cmp_eq_u32 s61, s99
    s_waitcnt lgkmcnt(0)
    s_cbranch_scc1 egnn_edge_kernel_evb7
egnn_edge_kernel_nextb7:
egnn_edge_kernel_loop:
    s_setprio 3
    ds_read_b64 v[164:165], v2 offset:256
    ds_read_b128 v[156:159], v5
    ds_read_u16 v5, v3 offset:256
    ds_read_b128 v[72:75], v4 offset:192
    ds_read_b128 v[76:79], v4 offset:208
    v_exp_f32 v48, v16
    v_mfma_f32_32x32x16_bf16 v[80:95], v[64:67], v[160:163], v[80:95]
    v_exp_f32 v49, v17
    v_exp_f32 v50, v18
    v_exp_f32 v51, v19
    v_exp_f32 v52, v20
    v_mfma_f32_32x32x16_bf16 v[96:111], v[68:71], v[160:163], v[96:111]
    ds_read_b128 v[160:163], v1 offset:0
    v_exp_f32 v53, v21
    v_exp_f32 v54, v22
    v_exp_f32 v55, v23
    s_waitcnt lgkmcnt(5)
    v_mfma_f32_32x32x8bf16_1k v[32:47], v[164:165], v[166:167], 0
    v_exp_f32 v56, v24
    v_exp_f32 v57, v25
    v_exp_f32 v58, v26
    v_exp_f32 v59, v27
    v_exp_f32 v60, v28
    v_exp_f32 v61, v29
    v_exp_f32 v62, v30
    v_exp_f32 v63, v31
    v_pk_add_f32 v[48:49], v[48:49], 1.0 op_sel_hi:[1,0]
    v_pk_add_f32 v[50:51], v[50:51], 1.0 op_sel_hi:[1,0]
    v_pk_add_f32 v[52:53], v[52:53], 1.0 op_sel_hi:[1,0]
    v_pk_add_f32 v[54:55], v[54:55], 1.0 op_sel_hi:[1,0]
    v_pk_add_f32 v[56:57], v[56:57], 1.0 op_sel_hi:[1,0]
    v_pk_add_f32 v[58:59], v[58:59], 1.0 op_sel_hi:[1,0]
    v_pk_add_f32 v[60:61], v[60:61], 1.0 op_sel_hi:[1,0]
    v_pk_add_f32 v[62:63], v[62:63], 1.0 op_sel_hi:[1,0]
    s_waitcnt lgkmcnt(1)
    v_mfma_f32_32x32x16_bf16 v[32:47], v[156:159], v[152:155], v[32:47]
    v_rcp_f32 v48, v48
    v_rcp_f32 v49, v49
    v_rcp_f32 v50, v50
    v_rcp_f32 v51, v51
    v_rcp_f32 v52, v52
    v_rcp_f32 v53, v53
    v_rcp_f32 v54, v54
    v_rcp_f32 v55, v55
    v_rcp_f32 v56, v56
    v_rcp_f32 v57, v57
    s_waitcnt vmcnt(8)
    v_mfma_f32_4x4x4bf16_1k v[32:35], v[144:145], v[120:121], v[32:35]
    v_rcp_f32 v58, v58
    buffer_load_dword v120, v72, s[24:27], 0 offen
    buffer_load_dword v121, v73, s[24:27], 0 offen
    v_mfma_f32_4x4x4bf16_1k v[36:39], v[144:145], v[122:123], v[36:39]
    v_rcp_f32 v59, v59
    buffer_load_dword v122, v74, s[24:27], 0 offen
    buffer_load_dword v123, v75, s[24:27], 0 offen
    v_mfma_f32_4x4x4bf16_1k v[40:43], v[144:145], v[124:125], v[40:43]
    v_rcp_f32 v60, v60
    buffer_load_dword v124, v76, s[24:27], 0 offen
    buffer_load_dword v125, v77, s[24:27], 0 offen
    v_mfma_f32_4x4x4bf16_1k v[44:47], v[144:145], v[126:127], v[44:47]
    v_rcp_f32 v61, v61
    buffer_load_dword v126, v78, s[24:27], 0 offen
    buffer_load_dword v127, v79, s[24:27], 0 offen
    v_rcp_f32 v62, v62
    v_rcp_f32 v63, v63
    v_pk_mul_f32 v[48:49], v[48:49], v[16:17]
    v_pk_mul_f32 v[50:51], v[50:51], v[18:19]
    v_pk_mul_f32 v[52:53], v[52:53], v[20:21]
    v_pk_mul_f32 v[54:55], v[54:55], v[22:23]
    v_pk_mul_f32 v[56:57], v[56:57], v[24:25]
    v_pk_mul_f32 v[58:59], v[58:59], v[26:27]
    v_pk_mul_f32 v[60:61], v[60:61], v[28:29]
    v_pk_mul_f32 v[62:63], v[62:63], v[30:31]
    v_cvt_pk_bf16_f32 v64, v48, v50
    v_cvt_pk_bf16_f32 v65, v52, v54
    v_cvt_pk_bf16_f32 v66, v56, v58
    v_cvt_pk_bf16_f32 v67, v60, v62
    v_cvt_pk_bf16_f32 v68, v49, v51
    v_cvt_pk_bf16_f32 v69, v53, v55
    v_cvt_pk_bf16_f32 v70, v57, v59
    v_cvt_pk_bf16_f32 v71, v61, v63
    s_add_u32 s61, s61, 1
    s_cmp_eq_u32 s61, s99
    s_waitcnt lgkmcnt(0)
    s_cbranch_scc1 egnn_edge_kernel_evc0
egnn_edge_kernel_nextc0:
    s_setprio 2
    ds_read_b64 v[164:165], v2 offset:512
    ds_read_b128 v[156:159], v5
    ds_read_u16 v5, v3 offset:384
    ds_read_b128 v[72:75], v4 offset:256
    ds_read_b128 v[76:79], v4 offset:272
    v_exp_f32 v48, v32
    v_mfma_f32_32x32x16_bf16 v[80:95], v[64:67], v[160:163], v[80:95]
    v_exp_f32 v49, v33
    v_exp_f32 v50, v34
    v_exp_f32 v51, v35
    v_exp_f32 v52, v36
    v_mfma_f32_32x32x16_bf16 v[96:111], v[68:71], v[160:163], v[96:111]
    ds_read_b128 v[160:163], v1 offset:1024
    v_exp_f32 v53, v37
    v_exp_f32 v54, v38
    v_exp_f32 v55, v39
    s_waitcnt lgkmcnt(5)
    v_mfma_f32_32x32x8bf16_1k v[16:31], v[164:165], v[166:167], 0
    v_exp_f32 v56, v40
    v_exp_f32 v57, v41
    v_exp_f32 v58, v42
    v_exp_f32 v59, v43
    v_exp_f32 v60, v44
    v_exp_f32 v61, v45
    v_exp_f32 v62, v46
    v_exp_f32 v63, v47
    v_pk_add_f32 v[48:49], v[48:49], 1.0 op_sel_hi:[1,0]
    v_pk_add_f32 v[50:51], v[50:51], 1.0 op_sel_hi:[1,0]
    v_pk_add_f32 v[52:53], v[52:53], 1.0 op_sel_hi:[1,0]
    v_pk_add_f32 v[54:55], v[54:55], 1.0 op_sel_hi:[1,0]
    v_pk_add_f32 v[56:57], v[56:57], 1.0 op_sel_hi:[1,0]
    v_pk_add_f32 v[58:59], v[58:59], 1.0 op_sel_hi:[1,0]
    v_pk_add_f32 v[60:61], v[60:61], 1.0 op_sel_hi:[1,0]
    v_pk_add_f32 v[62:63], v[62:63], 1.0 op_sel_hi:[1,0]
    s_waitcnt lgkmcnt(1)
    v_mfma_f32_32x32x16_bf16 v[16:31], v[156:159], v[152:155], v[16:31]
    v_rcp_f32 v48, v48
    v_rcp_f32 v49, v49
    v_rcp_f32 v50, v50
    v_rcp_f32 v51, v51
    v_rcp_f32 v52, v52
    v_rcp_f32 v53, v53
    v_rcp_f32 v54, v54
    v_rcp_f32 v55, v55
    v_rcp_f32 v56, v56
    v_rcp_f32 v57, v57
    s_waitcnt vmcnt(8)
    v_mfma_f32_4x4x4bf16_1k v[16:19], v[144:145], v[112:113], v[16:19]
    v_rcp_f32 v58, v58
    buffer_load_dword v112, v72, s[24:27], 0 offen
    buffer_load_dword v113, v73, s[24:27], 0 offen
    v_mfma_f32_4x4x4bf16_1k v[20:23], v[144:145], v[114:115], v[20:23]
    v_rcp_f32 v59, v59
    buffer_load_dword v114, v74, s[24:27], 0 offen
    buffer_load_dword v115, v75, s[24:27], 0 offen
    v_mfma_f32_4x4x4bf16_1k v[24:27], v[144:145], v[116:117], v[24:27]
    v_rcp_f32 v60, v60
    buffer_load_dword v116, v76, s[24:27], 0 offen
    buffer_load_dword v117, v77, s[24:27], 0 offen
    v_mfma_f32_4x4x4bf16_1k v[28:31], v[144:145], v[118:119], v[28:31]
    v_rcp_f32 v61, v61
    buffer_load_dword v118, v78, s[24:27], 0 offen
    buffer_load_dword v119, v79, s[24:27], 0 offen
    v_rcp_f32 v62, v62
    v_rcp_f32 v63, v63
    v_pk_mul_f32 v[48:49], v[48:49], v[32:33]
    v_pk_mul_f32 v[50:51], v[50:51], v[34:35]
    v_pk_mul_f32 v[52:53], v[52:53], v[36:37]
    v_pk_mul_f32 v[54:55], v[54:55], v[38:39]
    v_pk_mul_f32 v[56:57], v[56:57], v[40:41]
    v_pk_mul_f32 v[58:59], v[58:59], v[42:43]
    v_pk_mul_f32 v[60:61], v[60:61], v[44:45]
    v_pk_mul_f32 v[62:63], v[62:63], v[46:47]
    v_cvt_pk_bf16_f32 v64, v48, v50
    v_cvt_pk_bf16_f32 v65, v52, v54
    v_cvt_pk_bf16_f32 v66, v56, v58
    v_cvt_pk_bf16_f32 v67, v60, v62
    v_cvt_pk_bf16_f32 v68, v49, v51
    v_cvt_pk_bf16_f32 v69, v53, v55
    v_cvt_pk_bf16_f32 v70, v57, v59
    v_cvt_pk_bf16_f32 v71, v61, v63
    s_add_u32 s61, s61, 1
    s_cmp_eq_u32 s61, s99
    s_waitcnt lgkmcnt(0)
    s_cbranch_scc1 egnn_edge_kernel_evc1
egnn_edge_kernel_nextc1:
    s_setprio 1
    ds_read_b64 v[164:165], v2 offset:768
    ds_read_b128 v[156:159], v5
    ds_read_u16 v5, v3 offset:512
    ds_read_b128 v[72:75], v4 offset:320
    ds_read_b128 v[76:79], v4 offset:336
    v_exp_f32 v48, v16
    v_mfma_f32_32x32x16_bf16 v[80:95], v[64:67], v[160:163], v[80:95]
    v_exp_f32 v49, v17
    v_exp_f32 v50, v18
    v_exp_f32 v51, v19
    v_exp_f32 v52, v20
    v_mfma_f32_32x32x16_bf16 v[96:111], v[68:71], v[160:163], v[96:111]
    ds_read_b128 v[160:163], v1 offset:2048
    v_exp_f32 v53, v21
    v_exp_f32 v54, v22
    v_exp_f32 v55, v23
    s_waitcnt lgkmcnt(5)
    v_mfma_f32_32x32x8bf16_1k v[32:47], v[164:165], v[166:167], 0
    v_exp_f32 v56, v24
    v_exp_f32 v57, v25
    v_exp_f32 v58, v26
    v_exp_f32 v59, v27
    v_exp_f32 v60, v28
    v_exp_f32 v61, v29
    v_exp_f32 v62, v30
    v_exp_f32 v63, v31
    v_pk_add_f32 v[48:49], v[48:49], 1.0 op_sel_hi:[1,0]
    v_pk_add_f32 v[50:51], v[50:51], 1.0 op_sel_hi:[1,0]
    v_pk_add_f32 v[52:53], v[52:53], 1.0 op_sel_hi:[1,0]
    v_pk_add_f32 v[54:55], v[54:55], 1.0 op_sel_hi:[1,0]
    v_pk_add_f32 v[56:57], v[56:57], 1.0 op_sel_hi:[1,0]
    v_pk_add_f32 v[58:59], v[58:59], 1.0 op_sel_hi:[1,0]
    v_pk_add_f32 v[60:61], v[60:61], 1.0 op_sel_hi:[1,0]
    v_pk_add_f32 v[62:63], v[62:63], 1.0 op_sel_hi:[1,0]
    s_waitcnt lgkmcnt(1)
    v_mfma_f32_32x32x16_bf16 v[32:47], v[156:159], v[152:155], v[32:47]
    v_rcp_f32 v48, v48
    v_rcp_f32 v49, v49
    v_rcp_f32 v50, v50
    v_rcp_f32 v51, v51
    v_rcp_f32 v52, v52
    v_rcp_f32 v53, v53
    v_rcp_f32 v54, v54
    v_rcp_f32 v55, v55
    v_rcp_f32 v56, v56
    v_rcp_f32 v57, v57
    s_waitcnt vmcnt(8)
    v_mfma_f32_4x4x4bf16_1k v[32:35], v[144:145], v[120:121], v[32:35]
    v_rcp_f32 v58, v58
    buffer_load_dword v120, v72, s[24:27], 0 offen
    buffer_load_dword v121, v73, s[24:27], 0 offen
    v_mfma_f32_4x4x4bf16_1k v[36:39], v[144:145], v[122:123], v[36:39]
    v_rcp_f32 v59, v59
    buffer_load_dword v122, v74, s[24:27], 0 offen
    buffer_load_dword v123, v75, s[24:27], 0 offen
    v_mfma_f32_4x4x4bf16_1k v[40:43], v[144:145], v[124:125], v[40:43]
    v_rcp_f32 v60, v60
    buffer_load_dword v124, v76, s[24:27], 0 offen
    buffer_load_dword v125, v77, s[24:27], 0 offen
    v_mfma_f32_4x4x4bf16_1k v[44:47], v[144:145], v[126:127], v[44:47]
    v_rcp_f32 v61, v61
    buffer_load_dword v126, v78, s[24:27], 0 offen
    buffer_load_dword v127, v79, s[24:27], 0 offen
    v_rcp_f32 v62, v62
    v_rcp_f32 v63, v63
    v_pk_mul_f32 v[48:49], v[48:49], v[16:17]
    v_pk_mul_f32 v[50:51], v[50:51], v[18:19]
    v_pk_mul_f32 v[52:53], v[52:53], v[20:21]
    v_pk_mul_f32 v[54:55], v[54:55], v[22:23]
    v_pk_mul_f32 v[56:57], v[56:57], v[24:25]
    v_pk_mul_f32 v[58:59], v[58:59], v[26:27]
    v_pk_mul_f32 v[60:61], v[60:61], v[28:29]
    v_pk_mul_f32 v[62:63], v[62:63], v[30:31]
    v_cvt_pk_bf16_f32 v64, v48, v50
    v_cvt_pk_bf16_f32 v65, v52, v54
    v_cvt_pk_bf16_f32 v66, v56, v58
    v_cvt_pk_bf16_f32 v67, v60, v62
    v_cvt_pk_bf16_f32 v68, v49, v51
    v_cvt_pk_bf16_f32 v69, v53, v55
    v_cvt_pk_bf16_f32 v70, v57, v59
    v_cvt_pk_bf16_f32 v71, v61, v63
    s_add_u32 s61, s61, 1
    s_cmp_eq_u32 s61, s99
    s_waitcnt lgkmcnt(0)
    s_cbranch_scc1 egnn_edge_kernel_evc2
egnn_edge_kernel_nextc2:
    s_setprio 0
    ds_read_b64 v[164:165], v2 offset:1024
    ds_read_b128 v[156:159], v5
    ds_read_u16 v5, v3 offset:640
    ds_read_b128 v[72:75], v4 offset:384
    ds_read_b128 v[76:79], v4 offset:400
    v_exp_f32 v48, v32
    v_mfma_f32_32x32x16_bf16 v[80:95], v[64:67], v[160:163], v[80:95]
    v_exp_f32 v49, v33
    v_exp_f32 v50, v34
    v_exp_f32 v51, v35
    v_exp_f32 v52, v36
    v_mfma_f32_32x32x16_bf16 v[96:111], v[68:71], v[160:163], v[96:111]
    ds_read_b128 v[160:163], v1 offset:3072
    v_exp_f32 v53, v37
    v_exp_f32 v54, v38
    v_exp_f32 v55, v39
    s_waitcnt lgkmcnt(5)
    v_mfma_f32_32x32x8bf16_1k v[16:31], v[164:165], v[166:167], 0
    v_exp_f32 v56, v40
    v_exp_f32 v57, v41
    v_exp_f32 v58, v42
    v_exp_f32 v59, v43
    v_exp_f32 v60, v44
    v_exp_f32 v61, v45
    v_exp_f32 v62, v46
    v_exp_f32 v63, v47
    v_pk_add_f32 v[48:49], v[48:49], 1.0 op_sel_hi:[1,0]
    v_pk_add_f32 v[50:51], v[50:51], 1.0 op_sel_hi:[1,0]
    v_pk_add_f32 v[52:53], v[52:53], 1.0 op_sel_hi:[1,0]
    v_pk_add_f32 v[54:55], v[54:55], 1.0 op_sel_hi:[1,0]
    v_pk_add_f32 v[56:57], v[56:57], 1.0 op_sel_hi:[1,0]
    v_pk_add_f32 v[58:59], v[58:59], 1.0 op_sel_hi:[1,0]
    v_pk_add_f32 v[60:61], v[60:61], 1.0 op_sel_hi:[1,0]
    v_pk_add_f32 v[62:63], v[62:63], 1.0 op_sel_hi:[1,0]
    s_waitcnt lgkmcnt(1)
    v_mfma_f32_32x32x16_bf16 v[16:31], v[156:159], v[152:155], v[16:31]
    v_rcp_f32 v48, v48
    v_rcp_f32 v49, v49
    v_rcp_f32 v50, v50
    v_rcp_f32 v51, v51
    v_rcp_f32 v52, v52
    v_rcp_f32 v53, v53
    v_rcp_f32 v54, v54
    v_rcp_f32 v55, v55
    v_rcp_f32 v56, v56
    v_rcp_f32 v57, v57
    s_waitcnt vmcnt(8)
    v_mfma_f32_4x4x4bf16_1k v[16:19], v[144:145], v[112:113], v[16:19]
    v_rcp_f32 v58, v58
    buffer_load_dword v112, v72, s[24:27], 0 offen
    buffer_load_dword v113, v73, s[24:27], 0 offen
    v_mfma_f32_4x4x4bf16_1k v[20:23], v[144:145], v[114:115], v[20:23]
    v_rcp_f32 v59, v59
    buffer_load_dword v114, v74, s[24:27], 0 offen
    buffer_load_dword v115, v75, s[24:27], 0 offen
    v_mfma_f32_4x4x4bf16_1k v[24:27], v[144:145], v[116:117], v[24:27]
    v_rcp_f32 v60, v60
    buffer_load_dword v116, v76, s[24:27], 0 offen
    buffer_load_dword v117, v77, s[24:27], 0 offen
    v_mfma_f32_4x4x4bf16_1k v[28:31], v[144:145], v[118:119], v[28:31]
    v_rcp_f32 v61, v61
    buffer_load_dword v118, v78, s[24:27], 0 offen
    buffer_load_dword v119, v79, s[24:27], 0 offen
    v_rcp_f32 v62, v62
    v_rcp_f32 v63, v63
    v_pk_mul_f32 v[48:49], v[48:49], v[32:33]
    v_pk_mul_f32 v[50:51], v[50:51], v[34:35]
    v_pk_mul_f32 v[52:53], v[52:53], v[36:37]
    v_pk_mul_f32 v[54:55], v[54:55], v[38:39]
    v_pk_mul_f32 v[56:57], v[56:57], v[40:41]
    v_pk_mul_f32 v[58:59], v[58:59], v[42:43]
    v_pk_mul_f32 v[60:61], v[60:61], v[44:45]
    v_pk_mul_f32 v[62:63], v[62:63], v[46:47]
    v_add_u32 v1, 4096, v1
    v_add_u32 v2, 1024, v2
    v_add_u32 v3, 512, v3
    v_add_u32 v4, 256, v4
    v_cvt_pk_bf16_f32 v64, v48, v50
    v_cvt_pk_bf16_f32 v65, v52, v54
    v_cvt_pk_bf16_f32 v66, v56, v58
    v_cvt_pk_bf16_f32 v67, v60, v62
    v_cvt_pk_bf16_f32 v68, v49, v51
    v_cvt_pk_bf16_f32 v69, v53, v55
    v_cvt_pk_bf16_f32 v70, v57, v59
    v_cvt_pk_bf16_f32 v71, v61, v63
    s_add_u32 s61, s61, 1
    s_cmp_eq_u32 s61, s99
    s_waitcnt lgkmcnt(0)
    s_cbranch_scc1 egnn_edge_kernel_evc3
egnn_edge_kernel_nextc3:
    s_branch egnn_edge_kernel_loop
egnn_edge_kernel_eva0:
    s_cmp_eq_u32 s61, s54
    s_cbranch_scc0 egnn_edge_kernel_evfa0
    s_add_u32 s64, s64, 1
    s_min_u32 m0, s64, 4
    s_cmp_lt_u32 s64, 5
    s_movrels_b32 s54, s56
    s_cselect_b32 s3, 4096, 0
    v_add_u32 v6, s3, v6
    s_cselect_b32 s3, -1, 1000
    s_add_u32 s54, s54, s3
    ds_read_b128 v[152:155], v6
    s_min_u32 s99, s54, s63
    s_cmp_eq_u32 s61, s99
    s_cbranch_scc0 egnn_edge_kernel_nexta0
egnn_edge_kernel_evfa0:
    s_call_b64 s[74:75], egnn_edge_kernel_event
    s_cbranch_scc0 egnn_edge_kernel_nexta0
    s_branch egnn_edge_kernel_send
egnn_edge_kernel_eva1:
    s_cmp_eq_u32 s61, s54
    s_cbranch_scc0 egnn_edge_kernel_evfa1
    s_add_u32 s64, s64, 1
    s_min_u32 m0, s64, 4
    s_cmp_lt_u32 s64, 5
    s_movrels_b32 s54, s56
    s_cselect_b32 s3, 4096, 0
    v_add_u32 v6, s3, v6
    s_cselect_b32 s3, -1, 1000
    s_add_u32 s54, s54, s3
    ds_read_b128 v[152:155], v6
    s_min_u32 s99, s54, s63
    s_cmp_eq_u32 s61, s99
    s_cbranch_scc0 egnn_edge_kernel_nexta1
egnn_edge_kernel_evfa1:
    s_call_b64 s[74:75], egnn_edge_kernel_event
    s_cbranch_scc0 egnn_edge_kernel_nexta1
    s_branch egnn_edge_kernel_send
egnn_edge_kernel_eva2:
    s_cmp_eq_u32 s61, s54
    s_cbranch_scc0 egnn_edge_kernel_evfa2
    s_add_u32 s64, s64, 1
    s_min_u32 m0, s64, 4
    s_cmp_lt_u32 s64, 5
    s_movrels_b32 s54, s56
    s_cselect_b32 s3, 4096, 0
    v_add_u32 v6, s3, v6
    s_cselect_b32 s3, -1, 1000
    s_add_u32 s54, s54, s3
    ds_read_b128 v[152:155], v6
    s_min_u32 s99, s54, s63
    s_cmp_eq_u32 s61, s99
    s_cbranch_scc0 egnn_edge_kernel_nexta2
egnn_edge_kernel_evfa2:
    s_call_b64 s[74:75], egnn_edge_kernel_event
    s_cbranch_scc0 egnn_edge_kernel_nexta2
    s_branch egnn_edge_kernel_send
egnn_edge_kernel_eva3:
    s_cmp_eq_u32 s61, s54
    s_cbranch_scc0 egnn_edge_kernel_evfa3
    s_add_u32 s64, s64, 1
    s_min_u32 m0, s64, 4
    s_cmp_lt_u32 s64, 5
    s_movrels_b32 s54, s56
    s_cselect_b32 s3, 4096, 0
    v_add_u32 v6, s3, v6
    s_cselect_b32 s3, -1, 1000
    s_add_u32 s54, s54, s3
    ds_read_b128 v[152:155], v6
    s_min_u32 s99, s54, s63
    s_cmp_eq_u32 s61, s99
    s_cbranch_scc0 egnn_edge_kernel_nexta3
egnn_edge_kernel_evfa3:
    s_call_b64 s[74:75], egnn_edge_kernel_event
    s_cbranch_scc0 egnn_edge_kernel_nexta3
    s_branch egnn_edge_kernel_send
egnn_edge_kernel_eva4:
    s_cmp_eq_u32 s61, s54
    s_cbranch_scc0 egnn_edge_kernel_evfa4
    s_add_u32 s64, s64, 1
    s_min_u32 m0, s64, 4
    s_cmp_lt_u32 s64, 5
    s_movrels_b32 s54, s56
    s_cselect_b32 s3, 4096, 0
    v_add_u32 v6, s3, v6
    s_cselect_b32 s3, -1, 1000
    s_add_u32 s54, s54, s3
    ds_read_b128 v[152:155], v6
    s_min_u32 s99, s54, s63
    s_cmp_eq_u32 s61, s99
    s_cbranch_scc0 egnn_edge_kernel_nexta4
egnn_edge_kernel_evfa4:
    s_call_b64 s[74:75], egnn_edge_kernel_event
    s_cbranch_scc0 egnn_edge_kernel_nexta4
    s_branch egnn_edge_kernel_send
egnn_edge_kernel_eva5:
    s_cmp_eq_u32 s61, s54
    s_cbranch_scc0 egnn_edge_kernel_evfa5
    s_add_u32 s64, s64, 1
    s_min_u32 m0, s64, 4
    s_cmp_lt_u32 s64, 5
    s_movrels_b32 s54, s56
    s_cselect_b32 s3, 4096, 0
    v_add_u32 v6, s3, v6
    s_cselect_b32 s3, -1, 1000
    s_add_u32 s54, s54, s3
    ds_read_b128 v[152:155], v6
    s_min_u32 s99, s54, s63
    s_cmp_eq_u32 s61, s99
    s_cbranch_scc0 egnn_edge_kernel_nexta5
egnn_edge_kernel_evfa5:
    s_call_b64 s[74:75], egnn_edge_kernel_event
    s_cbranch_scc0 egnn_edge_kernel_nexta5
    s_branch egnn_edge_kernel_send
egnn_edge_kernel_eva6:
    s_cmp_eq_u32 s61, s54
    s_cbranch_scc0 egnn_edge_kernel_evfa6
    s_add_u32 s64, s64, 1
    s_min_u32 m0, s64, 4
    s_cmp_lt_u32 s64, 5
    s_movrels_b32 s54, s56
    s_cselect_b32 s3, 4096, 0
    v_add_u32 v6, s3, v6
    s_cselect_b32 s3, -1, 1000
    s_add_u32 s54, s54, s3
    ds_read_b128 v[152:155], v6
    s_min_u32 s99, s54, s63
    s_cmp_eq_u32 s61, s99
    s_cbranch_scc0 egnn_edge_kernel_nexta6
egnn_edge_kernel_evfa6:
    s_call_b64 s[74:75], egnn_edge_kernel_event
    s_cbranch_scc0 egnn_edge_kernel_nexta6
    s_branch egnn_edge_kernel_send
egnn_edge_kernel_eva7:
    s_cmp_eq_u32 s61, s54
    s_cbranch_scc0 egnn_edge_kernel_evfa7
    s_add_u32 s64, s64, 1
    s_min_u32 m0, s64, 4
    s_cmp_lt_u32 s64, 5
    s_movrels_b32 s54, s56
    s_cselect_b32 s3, 4096, 0
    v_add_u32 v6, s3, v6
    s_cselect_b32 s3, -1, 1000
    s_add_u32 s54, s54, s3
    ds_read_b128 v[152:155], v6
    s_min_u32 s99, s54, s63
    s_cmp_eq_u32 s61, s99
    s_cbranch_scc0 egnn_edge_kernel_nexta7
egnn_edge_kernel_evfa7:
    s_call_b64 s[74:75], egnn_edge_kernel_event
    s_cbranch_scc0 egnn_edge_kernel_nexta7
    s_branch egnn_edge_kernel_send
egnn_edge_kernel_evb0:
    s_cmp_eq_u32 s61, s54
    s_cbranch_scc0 egnn_edge_kernel_evfb0
    s_add_u32 s64, s64, 1
    s_min_u32 m0, s64, 4
    s_cmp_lt_u32 s64, 5
    s_movrels_b32 s54, s56
    s_cselect_b32 s3, 4096, 0
    v_add_u32 v6, s3, v6
    s_cselect_b32 s3, -1, 1000
    s_add_u32 s54, s54, s3
    ds_read_b128 v[152:155], v6
    s_min_u32 s99, s54, s63
    s_cmp_eq_u32 s61, s99
    s_cbranch_scc0 egnn_edge_kernel_nextb0
egnn_edge_kernel_evfb0:
    s_call_b64 s[74:75], egnn_edge_kernel_event
    s_cbranch_scc0 egnn_edge_kernel_nextb0
    s_branch egnn_edge_kernel_send
egnn_edge_kernel_evb1:
    s_cmp_eq_u32 s61, s54
    s_cbranch_scc0 egnn_edge_kernel_evfb1
    s_add_u32 s64, s64, 1
    s_min_u32 m0, s64, 4
    s_cmp_lt_u32 s64, 5
    s_movrels_b32 s54, s56
    s_cselect_b32 s3, 4096, 0
    v_add_u32 v6, s3, v6
    s_cselect_b32 s3, -1, 1000
    s_add_u32 s54, s54, s3
    ds_read_b128 v[152:155], v6
    s_min_u32 s99, s54, s63
    s_cmp_eq_u32 s61, s99
    s_cbranch_scc0 egnn_edge_kernel_nextb1
egnn_edge_kernel_evfb1:
    s_call_b64 s[74:75], egnn_edge_kernel_event
    s_cbranch_scc0 egnn_edge_kernel_nextb1
    s_branch egnn_edge_kernel_send
egnn_edge_kernel_evb2:
    s_cmp_eq_u32 s61, s54
    s_cbranch_scc0 egnn_edge_kernel_evfb2
    s_add_u32 s64, s64, 1
    s_min_u32 m0, s64, 4
    s_cmp_lt_u32 s64, 5
    s_movrels_b32 s54, s56
    s_cselect_b32 s3, 4096, 0
    v_add_u32 v6, s3, v6
    s_cselect_b32 s3, -1, 1000
    s_add_u32 s54, s54, s3
    ds_read_b128 v[152:155], v6
    s_min_u32 s99, s54, s63
    s_cmp_eq_u32 s61, s99
    s_cbranch_scc0 egnn_edge_kernel_nextb2
egnn_edge_kernel_evfb2:
    s_call_b64 s[74:75], egnn_edge_kernel_event
    s_cbranch_scc0 egnn_edge_kernel_nextb2
    s_branch egnn_edge_kernel_send
egnn_edge_kernel_evb3:
    s_cmp_eq_u32 s61, s54
    s_cbranch_scc0 egnn_edge_kernel_evfb3
    s_add_u32 s64, s64, 1
    s_min_u32 m0, s64, 4
    s_cmp_lt_u32 s64, 5
    s_movrels_b32 s54, s56
    s_cselect_b32 s3, 4096, 0
    v_add_u32 v6, s3, v6
    s_cselect_b32 s3, -1, 1000
    s_add_u32 s54, s54, s3
    ds_read_b128 v[152:155], v6
    s_min_u32 s99, s54, s63
    s_cmp_eq_u32 s61, s99
    s_cbranch_scc0 egnn_edge_kernel_nextb3
egnn_edge_kernel_evfb3:
    s_call_b64 s[74:75], egnn_edge_kernel_event
    s_cbranch_scc0 egnn_edge_kernel_nextb3
    s_branch egnn_edge_kernel_send
egnn_edge_kernel_evb4:
    s_cmp_eq_u32 s61, s54
    s_cbranch_scc0 egnn_edge_kernel_evfb4
    s_add_u32 s64, s64, 1
    s_min_u32 m0, s64, 4
    s_cmp_lt_u32 s64, 5
    s_movrels_b32 s54, s56
    s_cselect_b32 s3, 4096, 0
    v_add_u32 v6, s3, v6
    s_cselect_b32 s3, -1, 1000
    s_add_u32 s54, s54, s3
    ds_read_b128 v[152:155], v6
    s_min_u32 s99, s54, s63
    s_cmp_eq_u32 s61, s99
    s_cbranch_scc0 egnn_edge_kernel_nextb4
egnn_edge_kernel_evfb4:
    s_call_b64 s[74:75], egnn_edge_kernel_event
    s_cbranch_scc0 egnn_edge_kernel_nextb4
    s_branch egnn_edge_kernel_send
egnn_edge_kernel_evb5:
    s_cmp_eq_u32 s61, s54
    s_cbranch_scc0 egnn_edge_kernel_evfb5
    s_add_u32 s64, s64, 1
    s_min_u32 m0, s64, 4
    s_cmp_lt_u32 s64, 5
    s_movrels_b32 s54, s56
    s_cselect_b32 s3, 4096, 0
    v_add_u32 v6, s3, v6
    s_cselect_b32 s3, -1, 1000
    s_add_u32 s54, s54, s3
    ds_read_b128 v[152:155], v6
    s_min_u32 s99, s54, s63
    s_cmp_eq_u32 s61, s99
    s_cbranch_scc0 egnn_edge_kernel_nextb5
egnn_edge_kernel_evfb5:
    s_call_b64 s[74:75], egnn_edge_kernel_event
    s_cbranch_scc0 egnn_edge_kernel_nextb5
    s_branch egnn_edge_kernel_send
egnn_edge_kernel_evb6:
    s_cmp_eq_u32 s61, s54
    s_cbranch_scc0 egnn_edge_kernel_evfb6
    s_add_u32 s64, s64, 1
    s_min_u32 m0, s64, 4
    s_cmp_lt_u32 s64, 5
    s_movrels_b32 s54, s56
    s_cselect_b32 s3, 4096, 0
    v_add_u32 v6, s3, v6
    s_cselect_b32 s3, -1, 1000
    s_add_u32 s54, s54, s3
    ds_read_b128 v[152:155], v6
    s_min_u32 s99, s54, s63
    s_cmp_eq_u32 s61, s99
    s_cbranch_scc0 egnn_edge_kernel_nextb6
egnn_edge_kernel_evfb6:
    s_call_b64 s[74:75], egnn_edge_kernel_event
    s_cbranch_scc0 egnn_edge_kernel_nextb6
    s_branch egnn_edge_kernel_send
egnn_edge_kernel_evb7:
    s_cmp_eq_u32 s61, s54
    s_cbranch_scc0 egnn_edge_kernel_evfb7
    s_add_u32 s64, s64, 1
    s_min_u32 m0, s64, 4
    s_cmp_lt_u32 s64, 5
    s_movrels_b32 s54, s56
    s_cselect_b32 s3, 4096, 0
    v_add_u32 v6, s3, v6
    s_cselect_b32 s3, -1, 1000
    s_add_u32 s54, s54, s3
    ds_read_b128 v[152:155], v6
    s_min_u32 s99, s54, s63
    s_cmp_eq_u32 s61, s99
    s_cbranch_scc0 egnn_edge_kernel_nextb7
egnn_edge_kernel_evfb7:
    s_call_b64 s[74:75], egnn_edge_kernel_event
    s_cbranch_scc0 egnn_edge_kernel_nextb7
    s_branch egnn_edge_kernel_send
egnn_edge_kernel_evc0:
    s_cmp_eq_u32 s61, s54
    s_cbranch_scc0 egnn_edge_kernel_evfc0
    s_add_u32 s64, s64, 1
    s_min_u32 m0, s64, 4
    s_cmp_lt_u32 s64, 5
    s_movrels_b32 s54, s56
    s_cselect_b32 s3, 4096, 0
    v_add_u32 v6, s3, v6
    s_cselect_b32 s3, -1, 1000
    s_add_u32 s54, s54, s3
    ds_read_b128 v[152:155], v6
    s_min_u32 s99, s54, s63
    s_cmp_eq_u32 s61, s99
    s_cbranch_scc0 egnn_edge_kernel_nextc0
egnn_edge_kernel_evfc0:
    s_call_b64 s[74:75], egnn_edge_kernel_event
    s_cbranch_scc0 egnn_edge_kernel_nextc0
    s_branch egnn_edge_kernel_send
egnn_edge_kernel_evc1:
    s_cmp_eq_u32 s61, s54
    s_cbranch_scc0 egnn_edge_kernel_evfc1
    s_add_u32 s64, s64, 1
    s_min_u32 m0, s64, 4
    s_cmp_lt_u32 s64, 5
    s_movrels_b32 s54, s56
    s_cselect_b32 s3, 4096, 0
    v_add_u32 v6, s3, v6
    s_cselect_b32 s3, -1, 1000
    s_add_u32 s54, s54, s3
    ds_read_b128 v[152:155], v6
    s_min_u32 s99, s54, s63
    s_cmp_eq_u32 s61, s99
    s_cbranch_scc0 egnn_edge_kernel_nextc1
egnn_edge_kernel_evfc1:
    s_call_b64 s[74:75], egnn_edge_kernel_event
    s_cbranch_scc0 egnn_edge_kernel_nextc1
    s_branch egnn_edge_kernel_send
egnn_edge_kernel_evc2:
    s_cmp_eq_u32 s61, s54
    s_cbranch_scc0 egnn_edge_kernel_evfc2
    s_add_u32 s64, s64, 1
    s_min_u32 m0, s64, 4
    s_cmp_lt_u32 s64, 5
    s_movrels_b32 s54, s56
    s_cselect_b32 s3, 4096, 0
    v_add_u32 v6, s3, v6
    s_cselect_b32 s3, -1, 1000
    s_add_u32 s54, s54, s3
    ds_read_b128 v[152:155], v6
    s_min_u32 s99, s54, s63
    s_cmp_eq_u32 s61, s99
    s_cbranch_scc0 egnn_edge_kernel_nextc2
egnn_edge_kernel_evfc2:
    s_call_b64 s[74:75], egnn_edge_kernel_event
    s_cbranch_scc0 egnn_edge_kernel_nextc2
    s_branch egnn_edge_kernel_send
egnn_edge_kernel_evc3:
    s_cmp_eq_u32 s61, s54
    s_cbranch_scc0 egnn_edge_kernel_evfc3
    s_add_u32 s64, s64, 1
    s_min_u32 m0, s64, 4
    s_cmp_lt_u32 s64, 5
    s_movrels_b32 s54, s56
    s_cselect_b32 s3, 4096, 0
    v_add_u32 v6, s3, v6
    s_cselect_b32 s3, -1, 1000
    s_add_u32 s54, s54, s3
    ds_read_b128 v[152:155], v6
    s_min_u32 s99, s54, s63
    s_cmp_eq_u32 s61, s99
    s_cbranch_scc0 egnn_edge_kernel_nextc3
egnn_edge_kernel_evfc3:
    s_call_b64 s[74:75], egnn_edge_kernel_event
    s_cbranch_scc0 egnn_edge_kernel_nextc3
    s_branch egnn_edge_kernel_send
egnn_edge_kernel_event:
    s_setprio 3
    s_cmp_eq_u32 s61, s51
    s_cbranch_scc0 egnn_edge_kernel_last
    s_and_b32 s67, s67, 0
    ds_read_b128 v[72:75], v9 offset:0
    ds_read_b128 v[76:79], v9 offset:32
    ds_read_b128 v[156:159], v9 offset:64
    ds_read_b128 v[128:131], v9 offset:96
    v_cvt_pk_bf16_f32 v48, v80, v96
    v_cvt_pk_bf16_f32 v49, v81, v97
    v_cvt_pk_bf16_f32 v50, v82, v98
    v_cvt_pk_bf16_f32 v51, v83, v99
    v_cvt_pk_bf16_f32 v52, v84, v100
    v_cvt_pk_bf16_f32 v53, v85, v101
    v_cvt_pk_bf16_f32 v54, v86, v102
    v_cvt_pk_bf16_f32 v55, v87, v103
    v_cvt_pk_bf16_f32 v56, v88, v104
    v_cvt_pk_bf16_f32 v57, v89, v105
    v_cvt_pk_bf16_f32 v58, v90, v106
    v_cvt_pk_bf16_f32 v59, v91, v107
    v_cvt_pk_bf16_f32 v60, v92, v108
    v_cvt_pk_bf16_f32 v61, v93, v109
    v_cvt_pk_bf16_f32 v62, v94, v110
    v_cvt_pk_bf16_f32 v63, v95, v111
    s_or_b32 s3, s67, s81
    s_waitcnt lgkmcnt(0)
    v_mfma_f32_16x16x32_bf16 v[148:151], v[72:75], v[48:51], 0
    v_mfma_f32_16x16x32_bf16 v[148:151], v[76:79], v[52:55], v[148:151]
    v_mfma_f32_16x16x32_bf16 v[148:151], v[156:159], v[56:59], v[148:151]
    v_mfma_f32_16x16x32_bf16 v[148:151], v[128:131], v[60:63], v[148:151]
    s_cbranch_scc1 egnn_edge_kernel_rmwcm
    s_mov_b64 exec, s[90:91]
    ds_write_b128 v7, v[48:51] offset:0
    ds_write_b128 v7, v[52:55] offset:32
    ds_write_b128 v7, v[56:59] offset:64
    ds_write_b128 v7, v[60:63] offset:96
egnn_edge_kernel_wrotem:
    s_mov_b64 exec, -1
    v_mfma_f32_32x32x8bf16_1k v[80:95], v[10:11], v[10:11], 0
    v_mfma_f32_32x32x8bf16_1k v[96:111], v[10:11], v[10:11], 0
    v_add_u32 v7, 4352, v7
    s_add_u32 s11, s11, 1
    s_min_u32 m0, s11, 4
    s_mov_b64 exec, 0xffff
    s_movrels_b32 s51, s56
    ds_write2_b32 v8, v148, v149 offset1:16
    s_mov_b64 exec, -1
    v_add_u32 v8, 128, v8
    s_add_u32 s51, s51, 1
    s_cmp_lg_u32 s98, 0
    s_cbranch_scc1 egnn_edge_kernel_flagm
egnn_edge_kernel_noflagm:
    s_min_u32 s63, s51, s62
    s_min_u32 s99, s54, s63
    s_cmp_eq_u32 s61, s62
    s_cbranch_scc1 egnn_edge_kernel_last0
    s_setpc_b64 s[74:75]
egnn_edge_kernel_rmwcm:
    s_call_b64 s[96:97], egnn_edge_kernel_rmw
    s_branch egnn_edge_kernel_wrotem
egnn_edge_kernel_flagm:
    s_sub_u32 s98, s98, 1
    s_lshl_b32 s3, s48, 2
    s_add_u32 s3, s3, 84000
    v_mov_b32 v164, s3
    s_add_u32 s3, s82, 1
    v_mov_b32 v165, s3
    s_waitcnt lgkmcnt(0)
    ds_write_b32 v164, v165
    s_branch egnn_edge_kernel_noflagm
egnn_edge_kernel_last0:
    s_nop 7
egnn_edge_kernel_last:
    v_mfma_f32_32x32x16_bf16 v[80:95], v[64:67], v[160:163], v[80:95]
    v_mfma_f32_32x32x16_bf16 v[96:111], v[68:71], v[160:163], v[96:111]
    s_sub_u32 s67, s51, s62
    s_sub_u32 s67, s67, 1
    s_nop 5
    ds_read_b128 v[72:75], v9 offset:0
    ds_read_b128 v[76:79], v9 offset:32
    ds_read_b128 v[156:159], v9 offset:64
    ds_read_b128 v[128:131], v9 offset:96
    v_cvt_pk_bf16_f32 v48, v80, v96
    v_cvt_pk_bf16_f32 v49, v81, v97
    v_cvt_pk_bf16_f32 v50, v82, v98
    v_cvt_pk_bf16_f32 v51, v83, v99
    v_cvt_pk_bf16_f32 v52, v84, v100
    v_cvt_pk_bf16_f32 v53, v85, v101
    v_cvt_pk_bf16_f32 v54, v86, v102
    v_cvt_pk_bf16_f32 v55, v87, v103
    v_cvt_pk_bf16_f32 v56, v88, v104
    v_cvt_pk_bf16_f32 v57, v89, v105
    v_cvt_pk_bf16_f32 v58, v90, v106
    v_cvt_pk_bf16_f32 v59, v91, v107
    v_cvt_pk_bf16_f32 v60, v92, v108
    v_cvt_pk_bf16_f32 v61, v93, v109
    v_cvt_pk_bf16_f32 v62, v94, v110
    v_cvt_pk_bf16_f32 v63, v95, v111
    s_or_b32 s3, s67, s81
    s_waitcnt lgkmcnt(0)
    v_mfma_f32_16x16x32_bf16 v[148:151], v[72:75], v[48:51], 0
    v_mfma_f32_16x16x32_bf16 v[148:151], v[76:79], v[52:55], v[148:151]
    v_mfma_f32_16x16x32_bf16 v[148:151], v[156:159], v[56:59], v[148:151]
    v_mfma_f32_16x16x32_bf16 v[148:151], v[128:131], v[60:63], v[148:151]
    s_cbranch_scc1 egnn_edge_kernel_rmwce
    s_mov_b64 exec, s[90:91]
    ds_write_b128 v7, v[48:51] offset:0
    ds_write_b128 v7, v[52:55] offset:32
    ds_write_b128 v7, v[56:59] offset:64
    ds_write_b128 v7, v[60:63] offset:96
egnn_edge_kernel_wrotee:
    s_mov_b64 exec, -1
    v_mfma_f32_32x32x8bf16_1k v[80:95], v[10:11], v[10:11], 0
    v_mfma_f32_32x32x8bf16_1k v[96:111], v[10:11], v[10:11], 0
    v_add_u32 v7, 4352, v7
    s_add_u32 s11, s11, 1
    s_min_u32 m0, s11, 4
    s_mov_b64 exec, 0xffff
    s_movrels_b32 s51, s56
    ds_write2_b32 v8, v148, v149 offset1:16
    s_mov_b64 exec, -1
    v_add_u32 v8, 128, v8
    s_add_u32 s51, s51, 1
    s_cmp_lg_u32 s98, 0
    s_cbranch_scc1 egnn_edge_kernel_flage
egnn_edge_kernel_noflage:
    s_cmp_eq_u32 s61, s62
    s_setpc_b64 s[74:75]
egnn_edge_kernel_rmwce:
    s_call_b64 s[96:97], egnn_edge_kernel_rmw
    s_branch egnn_edge_kernel_wrotee
egnn_edge_kernel_flage:
    s_sub_u32 s98, s98, 1
    s_lshl_b32 s3, s48, 2
    s_add_u32 s3, s3, 84000
    v_mov_b32 v164, s3
    s_add_u32 s3, s82, 1
    v_mov_b32 v165, s3
    s_waitcnt lgkmcnt(0)
    ds_write_b32 v164, v165
    s_branch egnn_edge_kernel_noflage
egnn_edge_kernel_rmw:
    s_cmp_eq_u32 s67, 0
    s_cbranch_scc1 egnn_edge_kernel_rmw2
    s_lshl_b32 s3, s48, 2
    s_add_u32 s3, s3, 84000
    v_mov_b32 v164, s3
egnn_edge_kernel_poll:
    ds_read_b32 v165, v164
    ds_read_b128 v[16:19], v7 offset:0
    ds_read_b128 v[20:23], v7 offset:32
    ds_read_b128 v[24:27], v7 offset:64
    ds_read_b128 v[28:31], v7 offset:96
    s_waitcnt lgkmcnt(4)
    v_readfirstlane_b32 s3, v165
    s_nop 0
    s_cmp_gt_u32 s3, s82
    s_cbranch_scc0 egnn_edge_kernel_poll
    s_waitcnt lgkmcnt(3)
    v_lshlrev_b32 v32, 16, v16
    v_and_b32 v16, 0xffff0000, v16
    v_lshlrev_b32 v33, 16, v17
    v_and_b32 v17, 0xffff0000, v17
    v_lshlrev_b32 v34, 16, v18
    v_and_b32 v18, 0xffff0000, v18
    v_lshlrev_b32 v35, 16, v19
    v_and_b32 v19, 0xffff0000, v19
    s_waitcnt lgkmcnt(2)
    v_lshlrev_b32 v36, 16, v20
    v_and_b32 v20, 0xffff0000, v20
    v_lshlrev_b32 v37, 16, v21
    v_and_b32 v21, 0xffff0000, v21
    v_lshlrev_b32 v38, 16, v22
    v_and_b32 v22, 0xffff0000, v22
    v_lshlrev_b32 v39, 16, v23
    v_and_b32 v23, 0xffff0000, v23
    s_waitcnt lgkmcnt(1)
    v_lshlrev_b32 v40, 16, v24
    v_and_b32 v24, 0xffff0000, v24
    v_lshlrev_b32 v41, 16, v25
    v_and_b32 v25, 0xffff0000, v25
    v_lshlrev_b32 v42, 16, v26
    v_and_b32 v26, 0xffff0000, v26
    v_lshlrev_b32 v43, 16, v27
    v_and_b32 v27, 0xffff0000, v27
    s_waitcnt lgkmcnt(0)
    v_lshlrev_b32 v44, 16, v28
    v_and_b32 v28, 0xffff0000, v28
    v_lshlrev_b32 v45, 16, v29
    v_and_b32 v29, 0xffff0000, v29
    v_lshlrev_b32 v46, 16, v30
    v_and_b32 v30, 0xffff0000, v30
    v_lshlrev_b32 v47, 16, v31
    v_and_b32 v31, 0xffff0000, v31
    v_pk_add_f32 v[32:33], v[32:33], v[80:81]
    v_pk_add_f32 v[16:17], v[16:17], v[96:97]
    v_pk_add_f32 v[34:35], v[34:35], v[82:83]
    v_pk_add_f32 v[18:19], v[18:19], v[98:99]
    v_pk_add_f32 v[36:37], v[36:37], v[84:85]
    v_pk_add_f32 v[20:21], v[20:21], v[100:101]
    v_pk_add_f32 v[38:39], v[38:39], v[86:87]
    v_pk_add_f32 v[22:23], v[22:23], v[102:103]
    v_pk_add_f32 v[40:41], v[40:41], v[88:89]
    v_pk_add_f32 v[24:25], v[24:25], v[104:105]
    v_pk_add_f32 v[42:43], v[42:43], v[90:91]
    v_pk_add_f32 v[26:27], v[26:27], v[106:107]
    v_pk_add_f32 v[44:45], v[44:45], v[92:93]
    v_pk_add_f32 v[28:29], v[28:29], v[108:109]
    v_pk_add_f32 v[46:47], v[46:47], v[94:95]
    v_pk_add_f32 v[30:31], v[30:31], v[110:111]
    s_mov_b64 exec, s[90:91]
    v_cvt_pk_bf16_f32 v16, v32, v16
    v_cvt_pk_bf16_f32 v17, v33, v17
    v_cvt_pk_bf16_f32 v18, v34, v18
    v_cvt_pk_bf16_f32 v19, v35, v19
    ds_write_b128 v7, v[16:19] offset:0
    v_cvt_pk_bf16_f32 v20, v36, v20
    v_cvt_pk_bf16_f32 v21, v37, v21
    v_cvt_pk_bf16_f32 v22, v38, v22
    v_cvt_pk_bf16_f32 v23, v39, v23
    ds_write_b128 v7, v[20:23] offset:32
    v_cvt_pk_bf16_f32 v24, v40, v24
    v_cvt_pk_bf16_f32 v25, v41, v25
    v_cvt_pk_bf16_f32 v26, v42, v26
    v_cvt_pk_bf16_f32 v27, v43, v27
    ds_write_b128 v7, v[24:27] offset:64
    v_cvt_pk_bf16_f32 v28, v44, v28
    v_cvt_pk_bf16_f32 v29, v45, v29
    v_cvt_pk_bf16_f32 v30, v46, v30
    v_cvt_pk_bf16_f32 v31, v47, v31
    ds_write_b128 v7, v[28:31] offset:96
    s_setpc_b64 s[96:97]
egnn_edge_kernel_rmw2:
    s_mov_b64 exec, s[90:91]
    ds_read_b128 v[132:135], v7 offset:0
    s_waitcnt lgkmcnt(0)
    v_lshlrev_b32 v164, 16, v132
    v_and_b32 v132, 0xffff0000, v132
    v_add_f32 v164, v80, v164
    v_add_f32 v132, v96, v132
    v_cvt_pk_bf16_f32 v132, v164, v132
    v_lshlrev_b32 v164, 16, v133
    v_and_b32 v133, 0xffff0000, v133
    v_add_f32 v164, v81, v164
    v_add_f32 v133, v97, v133
    v_cvt_pk_bf16_f32 v133, v164, v133
    v_lshlrev_b32 v164, 16, v134
    v_and_b32 v134, 0xffff0000, v134
    v_add_f32 v164, v82, v164
    v_add_f32 v134, v98, v134
    v_cvt_pk_bf16_f32 v134, v164, v134
    v_lshlrev_b32 v164, 16, v135
    v_and_b32 v135, 0xffff0000, v135
    v_add_f32 v164, v83, v164
    v_add_f32 v135, v99, v135
    v_cvt_pk_bf16_f32 v135, v164, v135
    ds_write_b128 v7, v[132:135] offset:0
    ds_read_b128 v[132:135], v7 offset:32
    s_waitcnt lgkmcnt(0)
    v_lshlrev_b32 v164, 16, v132
    v_and_b32 v132, 0xffff0000, v132
    v_add_f32 v164, v84, v164
    v_add_f32 v132, v100, v132
    v_cvt_pk_bf16_f32 v132, v164, v132
    v_lshlrev_b32 v164, 16, v133
    v_and_b32 v133, 0xffff0000, v133
    v_add_f32 v164, v85, v164
    v_add_f32 v133, v101, v133
    v_cvt_pk_bf16_f32 v133, v164, v133
    v_lshlrev_b32 v164, 16, v134
    v_and_b32 v134, 0xffff0000, v134
    v_add_f32 v164, v86, v164
    v_add_f32 v134, v102, v134
    v_cvt_pk_bf16_f32 v134, v164, v134
    v_lshlrev_b32 v164, 16, v135
    v_and_b32 v135, 0xffff0000, v135
    v_add_f32 v164, v87, v164
    v_add_f32 v135, v103, v135
    v_cvt_pk_bf16_f32 v135, v164, v135
    ds_write_b128 v7, v[132:135] offset:32
    ds_read_b128 v[132:135], v7 offset:64
    s_waitcnt lgkmcnt(0)
    v_lshlrev_b32 v164, 16, v132
    v_and_b32 v132, 0xffff0000, v132
    v_add_f32 v164, v88, v164
    v_add_f32 v132, v104, v132
    v_cvt_pk_bf16_f32 v132, v164, v132
    v_lshlrev_b32 v164, 16, v133
    v_and_b32 v133, 0xffff0000, v133
    v_add_f32 v164, v89, v164
    v_add_f32 v133, v105, v133
    v_cvt_pk_bf16_f32 v133, v164, v133
    v_lshlrev_b32 v164, 16, v134
    v_and_b32 v134, 0xffff0000, v134
    v_add_f32 v164, v90, v164
    v_add_f32 v134, v106, v134
    v_cvt_pk_bf16_f32 v134, v164, v134
    v_lshlrev_b32 v164, 16, v135
    v_and_b32 v135, 0xffff0000, v135
    v_add_f32 v164, v91, v164
    v_add_f32 v135, v107, v135
    v_cvt_pk_bf16_f32 v135, v164, v135
    ds_write_b128 v7, v[132:135] offset:64
    ds_read_b128 v[132:135], v7 offset:96
    s_waitcnt lgkmcnt(0)
    v_lshlrev_b32 v164, 16, v132
    v_and_b32 v132, 0xffff0000, v132
    v_add_f32 v164, v92, v164
    v_add_f32 v132, v108, v132
    v_cvt_pk_bf16_f32 v132, v164, v132
    v_lshlrev_b32 v164, 16, v133
    v_and_b32 v133, 0xffff0000, v133
    v_add_f32 v164, v93, v164
    v_add_f32 v133, v109, v133
    v_cvt_pk_bf16_f32 v133, v164, v133
    v_lshlrev_b32 v164, 16, v134
    v_and_b32 v134, 0xffff0000, v134
    v_add_f32 v164, v94, v164
    v_add_f32 v134, v110, v134
    v_cvt_pk_bf16_f32 v134, v164, v134
    v_lshlrev_b32 v164, 16, v135
    v_and_b32 v135, 0xffff0000, v135
    v_add_f32 v164, v95, v164
    v_add_f32 v135, v111, v135
    v_cvt_pk_bf16_f32 v135, v164, v135
    ds_write_b128 v7, v[132:135] offset:96
    s_setpc_b64 s[96:97]
egnn_edge_kernel_send:
    s_setprio 0
    s_cmp_eq_u32 s65, 0
    s_cbranch_scc1 egnn_edge_kernel_late1
egnn_edge_kernel_wok:
    s_cmp_eq_u32 s81, 0
    s_cbranch_scc0 egnn_edge_kernel_nextwin
egnn_edge_kernel_final:
    v_add_u32 v14, 84672, v12
    v_pk_mul_f32 v[168:169], v[168:169], s[76:77]
    v_pk_mul_f32 v[170:171], v[170:171], s[76:77]
    v_pk_mul_f32 v[172:173], v[172:173], s[76:77]
    v_pk_mul_f32 v[174:175], v[174:175], s[76:77]
    v_pk_mul_f32 v[176:177], v[176:177], s[76:77]
    v_pk_mul_f32 v[178:179], v[178:179], s[76:77]
    v_pk_mul_f32 v[180:181], v[180:181], s[76:77]
    v_pk_mul_f32 v[182:183], v[182:183], s[76:77]
    v_pk_mul_f32 v[184:185], v[184:185], s[76:77]
    v_pk_mul_f32 v[186:187], v[186:187], s[76:77]
    v_pk_mul_f32 v[188:189], v[188:189], s[76:77]
    v_pk_mul_f32 v[190:191], v[190:191], s[76:77]
    s_waitcnt lgkmcnt(0)
    s_barrier
    ds_read_b128 v[16:19], v14 offset:0
    ds_read_b128 v[20:23], v14 offset:64
    ds_read_b128 v[24:27], v14 offset:128
    ds_read_b128 v[28:31], v14 offset:192
    ds_read_b128 v[32:35], v14 offset:256
    ds_read_b128 v[36:39], v14 offset:320
    ds_read_b128 v[40:43], v14 offset:384
    ds_read_b128 v[44:47], v14 offset:448
    v_and_b32 v4, 63, v0
    v_lshrrev_b32 v1, 4, v4
    v_and_b32 v2, 15, v4
    s_lshl_b32 s3, s47, 6
    v_lshl_add_u32 v2, v2, 2, s3
    v_lshl_add_u32 v3, v1, 11, v2
    v_mul_u32_u24 v1, 2176, v1
    v_add_u32 v1, v1, v2
    v_add_u32 v1, 106432, v1
    s_lshl_b32 s3, s45, 9
    s_lshl_b32 s78, s46, 9
    s_add_u32 s28, s20, s3
    s_addc_u32 s29, s21, 0
    s_mov_b32 s30, s78
    s_mov_b32 s31, 0x20000
    s_mul_i32 s3, s45, 6
    s_add_u32 s3, s3, 5120000
    s_add_u32 s32, s20, s3
    s_addc_u32 s33, s21, 0
    s_mov_b32 s34, 248
    s_mov_b32 s35, 0x20000
    s_waitcnt vmcnt(0)
    s_waitcnt lgkmcnt(7)
    v_mfma_f32_16x16x32_bf16 v[168:171], v[16:19], a[0:3], v[168:171]
    ds_read_b128 v[48:51], v14 offset:8704
    v_mfma_f32_16x16x32_bf16 v[172:175], v[16:19], a[4:7], v[172:175]
    ds_read_b32 v128, v1 offset:0
    ds_read_b32 v129, v1 offset:544
    s_waitcnt lgkmcnt(8)
    v_mfma_f32_16x16x32_bf16 v[168:171], v[20:23], a[8:11], v[168:171]
    ds_read_b128 v[52:55], v14 offset:8768
    v_mfma_f32_16x16x32_bf16 v[172:175], v[20:23], a[12:15], v[172:175]
    ds_read_b32 v130, v1 offset:1088
    ds_read_b32 v131, v1 offset:1632
    s_waitcnt lgkmcnt(9)
    v_mfma_f32_16x16x32_bf16 v[168:171], v[24:27], a[16:19], v[168:171]
    ds_read_b128 v[56:59], v14 offset:8832
    v_mfma_f32_16x16x32_bf16 v[172:175], v[24:27], a[20:23], v[172:175]
    ds_read_b32 v132, v1 offset:8704
    ds_read_b32 v133, v1 offset:9248
    s_waitcnt lgkmcnt(10)
    v_mfma_f32_16x16x32_bf16 v[168:171], v[28:31], a[24:27], v[168:171]
    ds_read_b128 v[60:63], v14 offset:8896
    v_mfma_f32_16x16x32_bf16 v[172:175], v[28:31], a[28:31], v[172:175]
    ds_read_b32 v134, v1 offset:9792
    ds_read_b32 v135, v1 offset:10336
    s_waitcnt lgkmcnt(11)
    v_mfma_f32_16x16x32_bf16 v[168:171], v[32:35], a[32:35], v[168:171]
    ds_read_b128 v[64:67], v14 offset:8960
    v_mfma_f32_16x16x32_bf16 v[172:175], v[32:35], a[36:39], v[172:175]
    ds_read_b32 v136, v1 offset:17408
    ds_read_b32 v137, v1 offset:17952
    s_waitcnt lgkmcnt(12)
    v_mfma_f32_16x16x32_bf16 v[168:171], v[36:39], a[40:43], v[168:171]
    ds_read_b128 v[68:71], v14 offset:9024
    v_mfma_f32_16x16x32_bf16 v[172:175], v[36:39], a[44:47], v[172:175]
    ds_read_b32 v138, v1 offset:18496
    ds_read_b32 v139, v1 offset:19040
    s_waitcnt lgkmcnt(13)
    v_mfma_f32_16x16x32_bf16 v[168:171], v[40:43], a[48:51], v[168:171]
    ds_read_b128 v[72:75], v14 offset:9088
    v_mfma_f32_16x16x32_bf16 v[172:175], v[40:43], a[52:55], v[172:175]
    s_waitcnt lgkmcnt(14)
    v_mfma_f32_16x16x32_bf16 v[168:171], v[44:47], a[56:59], v[168:171]
    ds_read_b128 v[76:79], v14 offset:9152
    v_mfma_f32_16x16x32_bf16 v[172:175], v[44:47], a[60:63], v[172:175]
    v_and_b32 v6, 2, v0
    v_lshlrev_b32 v6, 3, v6
    v_mov_b32 v7, 0x3f80
    v_lshlrev_b32 v6, v6, v7
    v_and_b32 v7, 1, v0
    v_mul_lo_u32 v5, v6, v7
    v_sub_u32 v4, v6, v5
    s_waitcnt lgkmcnt(0)
    ds_read_b128 v[80:83], v14 offset:17408
    ds_read_b128 v[84:87], v14 offset:17472
    ds_read_b128 v[88:91], v14 offset:17536
    ds_read_b128 v[92:95], v14 offset:17600
    ds_read_b128 v[96:99], v14 offset:17664
    ds_read_b128 v[100:103], v14 offset:17728
    ds_read_b128 v[104:107], v14 offset:17792
    ds_read_b128 v[108:111], v14 offset:17856
    v_mfma_f32_16x16x32_bf16 v[176:179], v[48:51], a[0:3], v[176:179]
    v_exp_f32 v144, v168
    v_mfma_f32_16x16x32_bf16 v[180:183], v[48:51], a[4:7], v[180:183]
    v_exp_f32 v145, v169
    v_exp_f32 v148, v170
    v_mfma_f32_16x16x32_bf16 v[176:179], v[52:55], a[8:11], v[176:179]
    v_exp_f32 v149, v171
    v_mfma_f32_16x16x32_bf16 v[180:183], v[52:55], a[12:15], v[180:183]
    v_exp_f32 v146, v172
    v_exp_f32 v147, v173
    v_mfma_f32_16x16x32_bf16 v[176:179], v[56:59], a[16:19], v[176:179]
    v_exp_f32 v150, v174
    v_mfma_f32_16x16x32_bf16 v[180:183], v[56:59], a[20:23], v[180:183]
    v_exp_f32 v151, v175
    v_fma_f32 v144, v144, s76, s76
    v_mfma_f32_16x16x32_bf16 v[176:179], v[60:63], a[24:27], v[176:179]
    v_fma_f32 v145, v145, s76, s76
    v_mfma_f32_16x16x32_bf16 v[180:183], v[60:63], a[28:31], v[180:183]
    v_fma_f32 v146, v146, s76, s76
    v_fma_f32 v147, v147, s76, s76
    v_mfma_f32_16x16x32_bf16 v[176:179], v[64:67], a[32:35], v[176:179]
    v_fma_f32 v148, v148, s76, s76
    v_mfma_f32_16x16x32_bf16 v[180:183], v[64:67], a[36:39], v[180:183]
    v_fma_f32 v149, v149, s76, s76
    v_fma_f32 v150, v150, s76, s76
    v_mfma_f32_16x16x32_bf16 v[176:179], v[68:71], a[40:43], v[176:179]
    v_fma_f32 v151, v151, s76, s76
    v_mfma_f32_16x16x32_bf16 v[180:183], v[68:71], a[44:47], v[180:183]
    v_rcp_f32 v144, v144
    v_rcp_f32 v145, v145
    v_mfma_f32_16x16x32_bf16 v[176:179], v[72:75], a[48:51], v[176:179]
    v_rcp_f32 v146, v146
    v_mfma_f32_16x16x32_bf16 v[180:183], v[72:75], a[52:55], v[180:183]
    v_rcp_f32 v147, v147
    v_rcp_f32 v148, v148
    v_mfma_f32_16x16x32_bf16 v[176:179], v[76:79], a[56:59], v[176:179]
    v_rcp_f32 v149, v149
    v_mfma_f32_16x16x32_bf16 v[180:183], v[76:79], a[60:63], v[180:183]
    v_rcp_f32 v150, v150
    v_rcp_f32 v151, v151
    v_pk_mul_f32 v[144:145], v[144:145], v[168:169]
    v_pk_mul_f32 v[146:147], v[146:147], v[172:173]
    v_pk_mul_f32 v[148:149], v[148:149], v[170:171]
    v_pk_mul_f32 v[150:151], v[150:151], v[174:175]
    s_nop 1
    v_mfma_f32_4x4x4bf16_1k v[144:147], v[4:5], v[128:129], v[144:147]
    v_mfma_f32_4x4x4bf16_1k v[148:151], v[4:5], v[130:131], v[148:151]
    s_waitcnt lgkmcnt(0)
    s_nop 1
    v_mfma_f32_16x16x32_bf16 v[184:187], v[80:83], a[0:3], v[184:187]
    v_cvt_pk_bf16_f32 v168, v144, v146
    v_cvt_pk_bf16_f32 v169, v145, v147
    v_mfma_f32_16x16x32_bf16 v[188:191], v[80:83], a[4:7], v[188:191]
    v_cvt_pk_bf16_f32 v170, v148, v150
    v_cvt_pk_bf16_f32 v171, v149, v151
    v_mfma_f32_16x16x32_bf16 v[184:187], v[84:87], a[8:11], v[184:187]
    buffer_store_dword v168, v3, s[28:31], 0 offen offset:0
    buffer_store_dword v169, v3, s[28:31], 0 offen offset:512
    v_mfma_f32_16x16x32_bf16 v[188:191], v[84:87], a[12:15], v[188:191]
    buffer_store_dword v170, v3, s[28:31], 0 offen offset:1024
    buffer_store_dword v171, v3, s[28:31], 0 offen offset:1536
    v_mfma_f32_16x16x32_bf16 v[184:187], v[88:91], a[16:19], v[184:187]
    v_add_u32 v3, 8192, v3
    v_exp_f32 v152, v176
    v_mfma_f32_16x16x32_bf16 v[188:191], v[88:91], a[20:23], v[188:191]
    v_exp_f32 v153, v177
    v_exp_f32 v156, v178
    v_mfma_f32_16x16x32_bf16 v[184:187], v[92:95], a[24:27], v[184:187]
    v_exp_f32 v157, v179
    v_exp_f32 v154, v180
    v_mfma_f32_16x16x32_bf16 v[188:191], v[92:95], a[28:31], v[188:191]
    v_exp_f32 v155, v181
    v_exp_f32 v158, v182
    v_mfma_f32_16x16x32_bf16 v[184:187], v[96:99], a[32:35], v[184:187]
    v_exp_f32 v159, v183
    v_fma_f32 v152, v152, s76, s76
    v_mfma_f32_16x16x32_bf16 v[188:191], v[96:99], a[36:39], v[188:191]
    v_fma_f32 v153, v153, s76, s76
    v_fma_f32 v154, v154, s76, s76
    v_mfma_f32_16x16x32_bf16 v[184:187], v[100:103], a[40:43], v[184:187]
    v_fma_f32 v155, v155, s76, s76
    v_fma_f32 v156, v156, s76, s76
    v_mfma_f32_16x16x32_bf16 v[188:191], v[100:103], a[44:47], v[188:191]
    v_fma_f32 v157, v157, s76, s76
    v_fma_f32 v158, v158, s76, s76
    v_mfma_f32_16x16x32_bf16 v[184:187], v[104:107], a[48:51], v[184:187]
    v_fma_f32 v159, v159, s76, s76
    v_rcp_f32 v152, v152
    v_mfma_f32_16x16x32_bf16 v[188:191], v[104:107], a[52:55], v[188:191]
    v_rcp_f32 v153, v153
    v_rcp_f32 v154, v154
    v_mfma_f32_16x16x32_bf16 v[184:187], v[108:111], a[56:59], v[184:187]
    v_rcp_f32 v155, v155
    v_rcp_f32 v156, v156
    v_mfma_f32_16x16x32_bf16 v[188:191], v[108:111], a[60:63], v[188:191]
    v_rcp_f32 v157, v157
    v_rcp_f32 v158, v158
    v_rcp_f32 v159, v159
    v_pk_mul_f32 v[152:153], v[152:153], v[176:177]
    v_pk_mul_f32 v[154:155], v[154:155], v[180:181]
    v_pk_mul_f32 v[156:157], v[156:157], v[178:179]
    v_pk_mul_f32 v[158:159], v[158:159], v[182:183]
    s_nop 1
    v_mfma_f32_4x4x4bf16_1k v[152:155], v[4:5], v[132:133], v[152:155]
    v_mfma_f32_4x4x4bf16_1k v[156:159], v[4:5], v[134:135], v[156:159]
    v_exp_f32 v160, v184
    v_exp_f32 v161, v185
    v_exp_f32 v164, v186
    v_exp_f32 v165, v187
    v_cvt_pk_bf16_f32 v176, v152, v154
    v_cvt_pk_bf16_f32 v177, v153, v155
    v_cvt_pk_bf16_f32 v178, v156, v158
    v_cvt_pk_bf16_f32 v179, v157, v159
    buffer_store_dword v176, v3, s[28:31], 0 offen offset:0
    buffer_store_dword v177, v3, s[28:31], 0 offen offset:512
    buffer_store_dword v178, v3, s[28:31], 0 offen offset:1024
    buffer_store_dword v179, v3, s[28:31], 0 offen offset:1536
    v_add_u32 v3, 8192, v3
    v_exp_f32 v162, v188
    v_exp_f32 v163, v189
    v_exp_f32 v166, v190
    v_exp_f32 v167, v191
    v_pk_fma_f32 v[160:161], v[160:161], s[76:77], s[76:77]
    v_pk_fma_f32 v[162:163], v[162:163], s[76:77], s[76:77]
    v_pk_fma_f32 v[164:165], v[164:165], s[76:77], s[76:77]
    v_pk_fma_f32 v[166:167], v[166:167], s[76:77], s[76:77]
    v_rcp_f32 v160, v160
    v_rcp_f32 v161, v161
    v_rcp_f32 v162, v162
    v_rcp_f32 v163, v163
    v_rcp_f32 v164, v164
    v_rcp_f32 v165, v165
    v_rcp_f32 v166, v166
    v_rcp_f32 v167, v167
    s_nop 0
    v_pk_mul_f32 v[160:161], v[160:161], v[184:185]
    v_pk_mul_f32 v[162:163], v[162:163], v[188:189]
    v_pk_mul_f32 v[164:165], v[164:165], v[186:187]
    v_pk_mul_f32 v[166:167], v[166:167], v[190:191]
    s_nop 1
    v_mfma_f32_4x4x4bf16_1k v[160:163], v[4:5], v[136:137], v[160:163]
    v_mfma_f32_4x4x4bf16_1k v[164:167], v[4:5], v[138:139], v[164:167]
    s_nop 3
    v_cvt_pk_bf16_f32 v184, v160, v162
    v_cvt_pk_bf16_f32 v185, v161, v163
    v_cvt_pk_bf16_f32 v186, v164, v166
    v_cvt_pk_bf16_f32 v187, v165, v167
    buffer_store_dword v184, v3, s[28:31], 0 offen offset:0
    buffer_store_dword v185, v3, s[28:31], 0 offen offset:512
    buffer_store_dword v186, v3, s[28:31], 0 offen offset:1024
    buffer_store_dword v187, v3, s[28:31], 0 offen offset:1536
    s_mov_b32 s76, 0xbf317218
    s_cmp_lt_u32 s47, 3
    s_cbranch_scc0 egnn_edge_kernel_nopos
    v_lshrrev_b32 v4, 2, v0
    v_and_b32 v5, 3, v0
    v_lshlrev_b32 v5, 1, v5
    v_lshl_add_u32 v6, v4, 3, v5
    ds_read_u16 v8, v6 offset:254
    v_lshlrev_b32 v6, 2, v0
    ds_read_b32 v16, v6 offset:1088
    ds_read_b32 v17, v6 offset:1728
    ds_read_b32 v18, v6 offset:2368
    ds_read_b32 v19, v6 offset:3008
    ds_read_b32 v20, v6 offset:3648
    ds_read_b32 v21, v6 offset:4288
    ds_read_b32 v22, v6 offset:4928
    ds_read_b32 v23, v6 offset:5568
    v_add_u32 v6, 84032, v6
    ds_read_b32 v7, v6
    s_waitcnt lgkmcnt(0)
    v_pk_add_f32 v[16:17], v[16:17], v[18:19]
    v_pk_add_f32 v[20:21], v[20:21], v[22:23]
    v_pk_add_f32 v[16:17], v[16:17], v[20:21]
    v_add_f32 v7, v7, v16
    v_add_f32 v7, v7, v17
    v_mad_u32_u24 v5, v4, 6, v5
    v_add_u32 v5, -2, v5
    v_cmp_gt_u32 vcc, s46, v4
    v_lshlrev_b32 v8, 16, v8
    v_fma_f32 v8, v7, s76, v8
    v_cvt_pk_bf16_f32 v8, v8, v8
    s_andn2_b64 exec, vcc, s[90:91]
    s_cbranch_execz egnn_edge_kernel_nopos
    buffer_store_short v8, v5, s[32:35], 0 offen
egnn_edge_kernel_nopos:
    s_mov_b64 exec, -1
egnn_edge_kernel_end:
    s_endpgm
egnn_edge_kernel_late1:
    s_mov_b32 s3, 131072
    buffer_load_dwordx4 a[0:3], v13, s[36:39], s3 offen offset:0
    buffer_load_dwordx4 a[4:7], v13, s[36:39], s3 offen offset:1024
    buffer_load_dwordx4 a[8:11], v13, s[36:39], s3 offen offset:2048
    buffer_load_dwordx4 a[12:15], v13, s[36:39], s3 offen offset:3072
    s_mov_b32 s3, 135168
    buffer_load_dwordx4 a[16:19], v13, s[36:39], s3 offen offset:0
    buffer_load_dwordx4 a[20:23], v13, s[36:39], s3 offen offset:1024
    buffer_load_dwordx4 a[24:27], v13, s[36:39], s3 offen offset:2048
    buffer_load_dwordx4 a[28:31], v13, s[36:39], s3 offen offset:3072
    s_mov_b32 s3, 139264
    buffer_load_dwordx4 a[32:35], v13, s[36:39], s3 offen offset:0
    buffer_load_dwordx4 a[36:39], v13, s[36:39], s3 offen offset:1024
    buffer_load_dwordx4 a[40:43], v13, s[36:39], s3 offen offset:2048
    buffer_load_dwordx4 a[44:47], v13, s[36:39], s3 offen offset:3072
    s_mov_b32 s3, 143360
    buffer_load_dwordx4 a[48:51], v13, s[36:39], s3 offen offset:0
    buffer_load_dwordx4 a[52:55], v13, s[36:39], s3 offen offset:1024
    buffer_load_dwordx4 a[56:59], v13, s[36:39], s3 offen offset:2048
    buffer_load_dwordx4 a[60:63], v13, s[36:39], s3 offen offset:3072
    s_add_u32 s65, s65, 1
    s_waitcnt vmcnt(0)
    v_add_u32 v14, 106432, v12
    ds_read_b128 v[48:51], v14 offset:0
    ds_read_b128 v[52:55], v14 offset:8704
    ds_read_b128 v[56:59], v14 offset:17408
    ds_read_b128 v[60:63], v14 offset:64
    ds_read_b128 v[72:75], v14 offset:8768
    ds_read_b128 v[76:79], v14 offset:17472
    s_waitcnt lgkmcnt(5)
    v_mfma_f32_16x16x32_bf16 v[168:171], v[48:51], a[0:3], 0
    v_mfma_f32_16x16x32_bf16 v[172:175], v[48:51], a[4:7], 0
    ds_read_b128 v[48:51], v14 offset:128
    s_waitcnt lgkmcnt(5)
    v_mfma_f32_16x16x32_bf16 v[176:179], v[52:55], a[0:3], 0
    v_mfma_f32_16x16x32_bf16 v[180:183], v[52:55], a[4:7], 0
    ds_read_b128 v[52:55], v14 offset:8832
    s_waitcnt lgkmcnt(5)
    v_mfma_f32_16x16x32_bf16 v[184:187], v[56:59], a[0:3], 0
    v_mfma_f32_16x16x32_bf16 v[188:191], v[56:59], a[4:7], 0
    ds_read_b128 v[56:59], v14 offset:17536
    s_waitcnt lgkmcnt(5)
    v_mfma_f32_16x16x32_bf16 v[168:171], v[60:63], a[8:11], v[168:171]
    v_mfma_f32_16x16x32_bf16 v[172:175], v[60:63], a[12:15], v[172:175]
    ds_read_b128 v[60:63], v14 offset:192
    s_waitcnt lgkmcnt(5)
    v_mfma_f32_16x16x32_bf16 v[176:179], v[72:75], a[8:11], v[176:179]
    v_mfma_f32_16x16x32_bf16 v[180:183], v[72:75], a[12:15], v[180:183]
    ds_read_b128 v[72:75], v14 offset:8896
    s_waitcnt lgkmcnt(5)
    v_mfma_f32_16x16x32_bf16 v[184:187], v[76:79], a[8:11], v[184:187]
    v_mfma_f32_16x16x32_bf16 v[188:191], v[76:79], a[12:15], v[188:191]
    ds_read_b128 v[76:79], v14 offset:17600
    s_waitcnt lgkmcnt(5)
    v_mfma_f32_16x16x32_bf16 v[168:171], v[48:51], a[16:19], v[168:171]
    v_mfma_f32_16x16x32_bf16 v[172:175], v[48:51], a[20:23], v[172:175]
    ds_read_b128 v[48:51], v14 offset:256
    s_waitcnt lgkmcnt(5)
    v_mfma_f32_16x16x32_bf16 v[176:179], v[52:55], a[16:19], v[176:179]
    v_mfma_f32_16x16x32_bf16 v[180:183], v[52:55], a[20:23], v[180:183]
    ds_read_b128 v[52:55], v14 offset:8960
    s_waitcnt lgkmcnt(5)
    v_mfma_f32_16x16x32_bf16 v[184:187], v[56:59], a[16:19], v[184:187]
    v_mfma_f32_16x16x32_bf16 v[188:191], v[56:59], a[20:23], v[188:191]
    ds_read_b128 v[56:59], v14 offset:17664
    s_waitcnt lgkmcnt(5)
    v_mfma_f32_16x16x32_bf16 v[168:171], v[60:63], a[24:27], v[168:171]
    v_mfma_f32_16x16x32_bf16 v[172:175], v[60:63], a[28:31], v[172:175]
    ds_read_b128 v[60:63], v14 offset:320
    s_waitcnt lgkmcnt(5)
    v_mfma_f32_16x16x32_bf16 v[176:179], v[72:75], a[24:27], v[176:179]
    v_mfma_f32_16x16x32_bf16 v[180:183], v[72:75], a[28:31], v[180:183]
    ds_read_b128 v[72:75], v14 offset:9024
    s_waitcnt lgkmcnt(5)
    v_mfma_f32_16x16x32_bf16 v[184:187], v[76:79], a[24:27], v[184:187]
    v_mfma_f32_16x16x32_bf16 v[188:191], v[76:79], a[28:31], v[188:191]
    ds_read_b128 v[76:79], v14 offset:17728
    s_waitcnt lgkmcnt(5)
    v_mfma_f32_16x16x32_bf16 v[168:171], v[48:51], a[32:35], v[168:171]
    v_mfma_f32_16x16x32_bf16 v[172:175], v[48:51], a[36:39], v[172:175]
    ds_read_b128 v[48:51], v14 offset:384
    s_waitcnt lgkmcnt(5)
    v_mfma_f32_16x16x32_bf16 v[176:179], v[52:55], a[32:35], v[176:179]
    v_mfma_f32_16x16x32_bf16 v[180:183], v[52:55], a[36:39], v[180:183]
    ds_read_b128 v[52:55], v14 offset:9088
    s_waitcnt lgkmcnt(5)
    v_mfma_f32_16x16x32_bf16 v[184:187], v[56:59], a[32:35], v[184:187]
    v_mfma_f32_16x16x32_bf16 v[188:191], v[56:59], a[36:39], v[188:191]
    ds_read_b128 v[56:59], v14 offset:17792
    s_waitcnt lgkmcnt(5)
    v_mfma_f32_16x16x32_bf16 v[168:171], v[60:63], a[40:43], v[168:171]
    v_mfma_f32_16x16x32_bf16 v[172:175], v[60:63], a[44:47], v[172:175]
    ds_read_b128 v[60:63], v14 offset:448
    s_waitcnt lgkmcnt(5)
    v_mfma_f32_16x16x32_bf16 v[176:179], v[72:75], a[40:43], v[176:179]
    v_mfma_f32_16x16x32_bf16 v[180:183], v[72:75], a[44:47], v[180:183]
    ds_read_b128 v[72:75], v14 offset:9152
    s_waitcnt lgkmcnt(5)
    v_mfma_f32_16x16x32_bf16 v[184:187], v[76:79], a[40:43], v[184:187]
    v_mfma_f32_16x16x32_bf16 v[188:191], v[76:79], a[44:47], v[188:191]
    ds_read_b128 v[76:79], v14 offset:17856
    s_waitcnt lgkmcnt(5)
    v_mfma_f32_16x16x32_bf16 v[168:171], v[48:51], a[48:51], v[168:171]
    v_mfma_f32_16x16x32_bf16 v[172:175], v[48:51], a[52:55], v[172:175]
    s_waitcnt lgkmcnt(4)
    v_mfma_f32_16x16x32_bf16 v[176:179], v[52:55], a[48:51], v[176:179]
    v_mfma_f32_16x16x32_bf16 v[180:183], v[52:55], a[52:55], v[180:183]
    s_waitcnt lgkmcnt(3)
    v_mfma_f32_16x16x32_bf16 v[184:187], v[56:59], a[48:51], v[184:187]
    v_mfma_f32_16x16x32_bf16 v[188:191], v[56:59], a[52:55], v[188:191]
    s_waitcnt lgkmcnt(2)
    v_mfma_f32_16x16x32_bf16 v[168:171], v[60:63], a[56:59], v[168:171]
    v_mfma_f32_16x16x32_bf16 v[172:175], v[60:63], a[60:63], v[172:175]
    s_waitcnt lgkmcnt(1)
    v_mfma_f32_16x16x32_bf16 v[176:179], v[72:75], a[56:59], v[176:179]
    v_mfma_f32_16x16x32_bf16 v[180:183], v[72:75], a[60:63], v[180:183]
    s_waitcnt lgkmcnt(0)
    v_mfma_f32_16x16x32_bf16 v[184:187], v[76:79], a[56:59], v[184:187]
    v_mfma_f32_16x16x32_bf16 v[188:191], v[76:79], a[60:63], v[188:191]
    s_mov_b32 s3, 262144
    buffer_load_dwordx4 a[0:3], v13, s[36:39], s3 offen offset:0
    buffer_load_dwordx4 a[4:7], v13, s[36:39], s3 offen offset:1024
    buffer_load_dwordx4 a[8:11], v13, s[36:39], s3 offen offset:2048
    buffer_load_dwordx4 a[12:15], v13, s[36:39], s3 offen offset:3072
    s_mov_b32 s3, 266240
    buffer_load_dwordx4 a[16:19], v13, s[36:39], s3 offen offset:0
    buffer_load_dwordx4 a[20:23], v13, s[36:39], s3 offen offset:1024
    buffer_load_dwordx4 a[24:27], v13, s[36:39], s3 offen offset:2048
    buffer_load_dwordx4 a[28:31], v13, s[36:39], s3 offen offset:3072
    s_mov_b32 s3, 270336
    buffer_load_dwordx4 a[32:35], v13, s[36:39], s3 offen offset:0
    buffer_load_dwordx4 a[36:39], v13, s[36:39], s3 offen offset:1024
    buffer_load_dwordx4 a[40:43], v13, s[36:39], s3 offen offset:2048
    buffer_load_dwordx4 a[44:47], v13, s[36:39], s3 offen offset:3072
    s_mov_b32 s3, 274432
    buffer_load_dwordx4 a[48:51], v13, s[36:39], s3 offen offset:0
    buffer_load_dwordx4 a[52:55], v13, s[36:39], s3 offen offset:1024
    buffer_load_dwordx4 a[56:59], v13, s[36:39], s3 offen offset:2048
    buffer_load_dwordx4 a[60:63], v13, s[36:39], s3 offen offset:3072
    s_branch egnn_edge_kernel_wok
egnn_edge_kernel_slowprep:
    s_max_u32 s3, s6, s7
    s_max_u32 s3, s3, s8
    s_max_u32 s3, s3, s9
    s_max_u32 s3, s3, s10
    s_add_u32 s3, s3, 159
    s_mul_hi_u32 s83, s3, 0x199999a
    s_waitcnt lgkmcnt(0)
    s_mov_b32 s81, 1
    s_mov_b32 s85, s6
    s_mov_b32 s86, s7
    s_mov_b32 s87, s8
    s_mov_b32 s88, s9
    s_mov_b32 s89, s10
    s_barrier
    v_mov_b32 v36, 0
    v_mov_b32 v37, s85
    s_add_u32 s3, s85, s86
    v_mov_b32 v38, s3
    s_add_u32 s3, s3, s87
    v_mov_b32 v39, s3
    s_add_u32 s3, s3, s88
    v_mov_b32 v40, s3
    v_mov_b32 v41, 0
    ds_write_b128 v33, v[36:39]
    ds_write_b64 v33, v[40:41] offset:16
    v_mov_b32 v24, 0
    v_mov_b32 v25, 0
    v_mov_b32 v26, 0
    v_mov_b32 v27, 0
    v_lshlrev_b32 v29, 4, v0
    v_add_u32 v29, 84672, v29
    ds_write_b128 v29, v[24:27]
    ds_write_b128 v29, v[24:27] offset:8192
    s_mov_b32 s3, 336
    v_cmp_gt_u32 vcc, s3, v0
    s_and_saveexec_b64 s[78:79], vcc
    ds_write_b128 v29, v[24:27] offset:16384
    s_mov_b64 exec, -1
    s_waitcnt lgkmcnt(0)
    s_barrier
    v_and_b32 v36, 0xffff, v18
    s_mov_b64 exec, s[90:91]
    ds_add_u32 v33, v36 offset:20
    s_mov_b64 exec, -1
    s_waitcnt lgkmcnt(0)
    s_barrier
    ds_read_b32 v36, v33 offset:20
    s_waitcnt lgkmcnt(0)
    v_readfirstlane_b32 s84, v36
    s_nop 1
    s_lshl_b32 s84, s84, 3
    s_add_u32 s28, s22, 7077888
    s_addc_u32 s29, s23, 0
    s_mov_b32 s30, 1280000
    s_mov_b32 s31, 0x20000
    v_add_u32 v48, 0, v17
    v_add_u32 v49, 0, v16
egnn_edge_kernel_senum:
    v_cmp_lt_u32 s[68:69], v48, v35
    s_cmp_eq_u64 s[68:69], 0
    s_cbranch_scc1 egnn_edge_kernel_senum_done
    buffer_load_dwordx2 v[36:37], v49, s[32:35], 0 offen
    v_add_u32 v48, 4, v48
    v_add_u32 v49, 32, v49
    s_waitcnt vmcnt(0)
    v_lshrrev_b32 v42, 19, v37
    v_lshl_add_u32 v45, v42, 2, v33
    s_mov_b64 exec, s[68:69]
    ds_add_rtn_u32 v45, v45, v34
    s_mov_b64 exec, -1
    s_waitcnt lgkmcnt(0)
    v_lshlrev_b32 v45, 3, v45
    s_mov_b64 exec, s[68:69]
    buffer_store_dwordx2 v[36:37], v45, s[28:31], s84 offen
    s_mov_b64 exec, -1
    s_mov_b64 exec, -1
    s_branch egnn_edge_kernel_senum
egnn_edge_kernel_senum_done:
    s_waitcnt vmcnt(0)
    s_barrier
    s_branch egnn_edge_kernel_winfill
egnn_edge_kernel_nextwin:
    s_add_u32 s82, s82, 1
    s_cmp_eq_u32 s82, s83
    s_cbranch_scc1 egnn_edge_kernel_final
    s_mov_b32 s81, 2
    s_setprio 0
    s_waitcnt vmcnt(0) lgkmcnt(0)
    s_barrier
    v_lshlrev_b32 v28, 2, v0
    ds_read_b32 v32, v28 offset:1088
    ds_read_b32 v33, v28 offset:1728
    ds_read_b32 v34, v28 offset:2368
    ds_read_b32 v35, v28 offset:3008
    ds_read_b32 v36, v28 offset:3648
    ds_read_b32 v37, v28 offset:4288
    ds_read_b32 v38, v28 offset:4928
    ds_read_b32 v39, v28 offset:5568
    v_add_u32 v28, 84032, v28
    ds_read_b32 v29, v28
    s_waitcnt lgkmcnt(0)
    v_pk_add_f32 v[32:33], v[32:33], v[34:35]
    v_pk_add_f32 v[36:37], v[36:37], v[38:39]
    v_pk_add_f32 v[32:33], v[32:33], v[36:37]
    v_add_f32 v29, v29, v32
    v_add_f32 v29, v29, v33
    s_mov_b32 s3, 160
    v_cmp_gt_u32 vcc, s3, v0
    s_and_saveexec_b64 s[78:79], vcc
    ds_write_b32 v28, v29
    s_mov_b64 exec, -1
    s_waitcnt lgkmcnt(0)
    s_barrier
    v_mov_b32 v24, 0
    v_mov_b32 v25, 0
    v_mov_b32 v26, 0
    v_mov_b32 v27, 0
    v_lshlrev_b32 v29, 4, v0
    v_add_u32 v29, 28928, v29
    s_mov_b32 s3, 368
    ds_write_b128 v29, v[24:27]
    v_add_u32 v29, 8192, v29
    ds_write_b128 v29, v[24:27]
    v_add_u32 v29, 8192, v29
    ds_write_b128 v29, v[24:27]
    v_add_u32 v29, 8192, v29
    ds_write_b128 v29, v[24:27]
    v_add_u32 v29, 8192, v29
    ds_write_b128 v29, v[24:27]
    v_add_u32 v29, 8192, v29
    ds_write_b128 v29, v[24:27]
    v_add_u32 v29, 8192, v29
    v_cmp_gt_u32 vcc, s3, v0
    s_and_saveexec_b64 s[78:79], vcc
    ds_write_b128 v29, v[24:27]
    s_mov_b64 exec, -1
    v_and_b32 v14, 63, v0
egnn_edge_kernel_winfill:
    s_add_u32 s28, s22, 7077888
    s_addc_u32 s29, s23, 0
    s_mov_b32 s30, 1280000
    s_mov_b32 s31, 0x20000
    s_mul_i32 s80, s82, 160
    s_lshl_b32 s78, s80, 3
    s_add_u32 s78, s78, s84
    v_lshlrev_b32 v30, 3, v0
    s_mov_b32 s92, 160
    v_cmp_gt_u32 s[68:69], s92, v0
    s_max_u32 s3, s85, s80
    s_sub_u32 s3, s3, s80
    s_min_u32 s6, s3, 160
    buffer_load_dwordx2 v[36:37], v30, s[28:31], s78 offen
    s_lshl_b32 s3, s85, 3
    s_add_u32 s78, s78, s3
    s_max_u32 s3, s86, s80
    s_sub_u32 s3, s3, s80
    s_min_u32 s7, s3, 160
    buffer_load_dwordx2 v[38:39], v30, s[28:31], s78 offen
    s_lshl_b32 s3, s86, 3
    s_add_u32 s78, s78, s3
    s_max_u32 s3, s87, s80
    s_sub_u32 s3, s3, s80
    s_min_u32 s8, s3, 160
    buffer_load_dwordx2 v[40:41], v30, s[28:31], s78 offen
    s_lshl_b32 s3, s87, 3
    s_add_u32 s78, s78, s3
    s_max_u32 s3, s88, s80
    s_sub_u32 s3, s3, s80
    s_min_u32 s9, s3, 160
    buffer_load_dwordx2 v[42:43], v30, s[28:31], s78 offen
    s_lshl_b32 s3, s88, 3
    s_add_u32 s78, s78, s3
    s_max_u32 s3, s89, s80
    s_sub_u32 s3, s3, s80
    s_min_u32 s10, s3, 160
    buffer_load_dwordx2 v[44:45], v30, s[28:31], s78 offen
    s_lshl_b32 s3, s89, 3
    s_add_u32 s78, s78, s3
    s_waitcnt vmcnt(0)
    s_mov_b64 exec, s[68:69]
    ds_write_b64 v30, v[36:37] offset:1088
    ds_write_b64 v30, v[38:39] offset:2624
    ds_write_b64 v30, v[40:41] offset:4160
    ds_write_b64 v30, v[42:43] offset:5696
    ds_write_b64 v30, v[44:45] offset:7232
    s_mov_b64 exec, -1
    s_waitcnt lgkmcnt(0)
    s_barrier
    s_branch egnn_edge_kernel_build
.section .rodata,"a"
.p2align 6
.amdhsa_kernel egnn_prep_kernel
  .amdhsa_next_free_vgpr 184
  .amdhsa_next_free_sgpr 58
  .amdhsa_accum_offset 184
  .amdhsa_group_segment_fixed_size 0
  .amdhsa_kernarg_size 88
  .amdhsa_user_sgpr_count 2
  .amdhsa_user_sgpr_kernarg_segment_ptr 1
  .amdhsa_system_sgpr_workgroup_id_x 1
.end_amdhsa_kernel
.p2align 6
.amdhsa_kernel egnn_edge_kernel
  .amdhsa_next_free_vgpr 256
  .amdhsa_next_free_sgpr 102
  .amdhsa_accum_offset 192
  .amdhsa_group_segment_fixed_size 0
  .amdhsa_kernarg_size 88
  .amdhsa_user_sgpr_count 2
  .amdhsa_user_sgpr_kernarg_segment_ptr 1
  .amdhsa_system_sgpr_workgroup_id_x 1
.end_amdhsa_kernel
```
